```python
import torch

def _softmax(x, axis=-1):
    return torch.softmax(x, dim=axis)
def _gelu(x):
    return torch.nn.functional.gelu(x, approximate="tanh")
def _silu(x):
    return torch.nn.functional.silu(x)
def _sigmoid(x):
    return torch.sigmoid(x)
def _layernorm(x, axis=-1, eps=1e-5):
    m = x.mean(dim=axis, keepdim=True)
    v = x.var(dim=axis, keepdim=True, unbiased=False)
    return (x - m) / torch.sqrt(v + eps)
def _scatter_add(tgt, idx, src, axis=0):
    return tgt.clone().index_add_(axis, idx, src)
def _segment_sum(src, seg, n):
    out = torch.zeros((n,) + src.shape[1:], dtype=src.dtype)
    return out.index_add_(0, seg, src)
def _pad(x, pw):
    flat = tuple(v for pair in reversed(pw) for v in pair)
    return torch.nn.functional.pad(x, flat)

kernel_name = 'concat_heads__ssm_conv_s5__linear_kernel_hedgehog__prompt'

def setup_inputs():

    _w = (lambda a: (lambda t: t.to(torch.bfloat16) if t.is_floating_point() else t)(torch.as_tensor(a)))
    def _A_setup():
        B, S, D = 1, 2048, 512
        P = D
        Lambda_re = -0.5 * (lambda _x: torch.exp(torch.as_tensor(_x)))((lambda *s: torch.randn(*s, dtype=torch.bfloat16) * 0.8)(P))
        Lambda_im = (lambda *s: torch.randn(*s, dtype=torch.bfloat16) * 0.8)(P) * 1.0
        B_re = (lambda *s: torch.randn(*s, dtype=torch.bfloat16) * 0.8)(P, D) * (D ** -0.5)
        B_im = (lambda *s: torch.randn(*s, dtype=torch.bfloat16) * 0.8)(P, D) * (D ** -0.5)
        C_re = (lambda *s: torch.randn(*s, dtype=torch.bfloat16) * 0.8)(D, P) * (P ** -0.5)
        C_im = (lambda *s: torch.randn(*s, dtype=torch.bfloat16) * 0.8)(D, P) * (P ** -0.5)
        log_dt = (lambda *s: torch.randn(*s, dtype=torch.bfloat16) * 0.8)(P) * 0.3 - 2.0
        Dskip = (lambda *s: torch.randn(*s, dtype=torch.bfloat16) * 0.8)(D)
        return {
            "x": _w((lambda *s: torch.randn(*s, dtype=torch.bfloat16) * 0.05)(B, S, D)),
            "Lambda_re": _w(Lambda_re),
            "Lambda_im": _w(Lambda_im),
            "B_re": _w(B_re),
            "B_im": _w(B_im),
            "C_re": _w(C_re),
            "C_im": _w(C_im),
            "log_dt": _w(log_dt),
            "Dskip": _w(Dskip),
        }
    _A_in = _A_setup()

    def _B_setup():
        B, S, D, H = 1, 2048, 512, 32
        Dh = D // H
        return {
            "x": _w((lambda *s: torch.randn(*s, dtype=torch.bfloat16) * 0.4)(B, S, D)),
            "wqkv": _w((lambda *s: torch.randn(*s, dtype=torch.bfloat16) * 0.4)(D, 3 * D)),
            "w_phi": _w((lambda *s: torch.randn(*s, dtype=torch.bfloat16) * 0.4)(H, Dh, Dh) * (Dh ** -0.5)),
            "wo": _w((lambda *s: torch.randn(*s, dtype=torch.bfloat16) * 0.05)(D, D)),
        }
    _B_in = _B_setup()

    return {
        "A_x": _A_in["x"],
        "A_Lambda_re": _A_in["Lambda_re"],
        "A_Lambda_im": _A_in["Lambda_im"],
        "A_B_re": _A_in["B_re"],
        "A_B_im": _A_in["B_im"],
        "A_C_re": _A_in["C_re"],
        "A_C_im": _A_in["C_im"],
        "A_log_dt": _A_in["log_dt"],
        "A_Dskip": _A_in["Dskip"],
        "B_x": _B_in["x"],
        "B_wqkv": _B_in["wqkv"],
        "B_w_phi": _B_in["w_phi"],
        "B_wo": _B_in["wo"],
    }

def reference(A_x, A_Lambda_re, A_Lambda_im, A_B_re, A_B_im, A_C_re, A_C_im, A_log_dt, A_Dskip, B_x, B_wqkv, B_w_phi, B_wo):
    def _A_ref(x, Lambda_re, Lambda_im, B_re, B_im, C_re, C_im, log_dt, Dskip):
        Bsz, L, H = x.shape
        Lam = Lambda_re + 1j * Lambda_im
        Bmat = B_re + 1j * B_im
        Cmat = C_re + 1j * C_im
        dt = torch.exp(log_dt)
        Lam_bar = torch.exp(dt * Lam)
        B_bar = ((Lam_bar - 1.0) / Lam)[:, None] * Bmat
        Bu = torch.einsum("bld,pd->blp", x + 0j, B_bar)
        h = torch.zeros_like(Bu[:, 0, :])
        hs = []
        for t in range(L):
            h = Lam_bar[None, :] * h + Bu[:, t, :]
            hs.append(h)
        hseq = torch.stack(hs, 1)
        y = 2.0 * torch.einsum("blp,dp->bld", hseq, Cmat).real + x * Dskip[None, None, :]
        return y

    def _B_ref(x, wqkv, w_phi, wo):
        B, S, D = x.shape
        H = 32; Dh = D // H
        qkv = (lambda x, *d: x.permute(*d))((x @ wqkv).reshape(B, S, 3, H, Dh), 2, 0, 3, 1, 4)
        q, k, v = qkv[0], qkv[1], qkv[2]
        pq = torch.einsum("bhsd,hdf->bhsf", q, w_phi)
        pk = torch.einsum("bhsd,hdf->bhsf", k, w_phi)
        phi_q = torch.concatenate([_softmax(pq, axis=-1), _softmax(-pq, axis=-1)], axis=-1)
        phi_k = torch.concatenate([_softmax(pk, axis=-1), _softmax(-pk, axis=-1)], axis=-1)
        kv = torch.einsum("bhsf,bhsd->bhfd", phi_k, v)
        z  = torch.einsum("bhsf->bhf", phi_k)
        num = torch.einsum("bhqf,bhfd->bhqd", phi_q, kv)
        den = torch.einsum("bhqf,bhf->bhq", phi_q, z)[..., None] + 1e-6
        o = num / den
        return (lambda x, *d: x.permute(*d))(o, 0, 2, 1, 3).reshape(B, S, D) @ wo

    a = _A_ref(A_x, A_Lambda_re, A_Lambda_im, A_B_re, A_B_im, A_C_re, A_C_im, A_log_dt, A_Dskip)
    b = _B_ref(B_x, B_wqkv, B_w_phi, B_wo)
    return torch.concatenate([a, b], axis=-1)
```

```asm
; @launch grid=(256,1,1) block=(256,1,1) lds=163840
.amdgcn_target "amdgcn-amd-amdhsa--gfx950"
.text
.globl concat_heads__ssm_conv_s5__linear_kernel_hedgehog__prompt_kernel
.p2align 8
.type concat_heads__ssm_conv_s5__linear_kernel_hedgehog__prompt_kernel,@function
concat_heads__ssm_conv_s5__linear_kernel_hedgehog__prompt_kernel:
    s_cmp_ge_u32 s2, 256
    s_cbranch_scc1 L_end
    s_load_dwordx16 s[64:79], s[0:1], 0
    s_load_dwordx16 s[80:95], s[0:1], 64
    v_and_b32 v1, 63, v0
    v_lshrrev_b32 v2, 6, v0
    s_lshr_b32 s30, s2, 3
    v_readfirstlane_b32 s3, v2
    s_and_b32 s32, s2, 3
    s_lshl_b32 s4, s32, 2
    s_lshr_b32 s33, s30, 3
    s_add_u32 s4, s4, s33
    s_and_b32 s5, s30, 7
    s_lshl_b32 s6, s33, 1
    s_add_u32 s6, s6, s5
    s_and_b32 s6, s6, 7
    s_add_u32 s47, s5, s33
    s_and_b32 s47, s47, 1
    s_lshl_b32 s47, s47, 2
    s_lshr_b32 s28, s3, 1
    s_and_b32 s29, s3, 1
    s_lshl_b32 s48, s3, 12
    s_lshl_b32 s34, s30, 9
    s_lshl_b32 s46, s3, 7
    s_add_u32 s34, s34, s46
    v_and_b32 v7, 1, v0
    v_lshl_add_u32 v7, v7, 14, s34
    v_lshrrev_b32 v3, 3, v1
    v_and_b32 v4, 7, v1
    v_and_b32 v5, 31, v1
    v_lshrrev_b32 v6, 5, v1
    s_bitcmp0_b32 s2, 2
    s_cbranch_scc0 L_roleA
L_roleB:
    s_getpc_b64 s[36:37]
L_pcB:
    s_add_u32 s36, s36, L_mainB-L_pcB
    s_addc_u32 s37, s37, 0
    global_load_dword v254, v7, s[36:37]
    v_lshrrev_b32 v9, 1, v3
    v_xor_b32 v9, v9, v4
    v_lshlrev_b32 v9, 4, v9
    v_lshl_add_u32 v10, v3, 10, v9
    s_lshl_b32 s32, s4, 17
    s_lshl_b32 s46, s3, 15
    s_add_u32 s32, s32, s46
    v_add_u32_e64 v16, s32, v10
    v_xor_b32 v11, 64, v16
    v_add_u32 v17, 7168, v11
    v_add_u32 v18, 14336, v16
    v_add_u32 v19, 21504, v11
    v_bfe_u32 v9, v3, 1, 1
    v_lshlrev_b32 v9, 2, v9
    v_xor_b32 v9, v9, v4
    v_lshlrev_b32 v9, 4, v9
    s_lshl_b32 s32, s5, 7
    v_add_u32 v9, s32, v9
    s_lshl_b32 s33, s29, 5
    v_add_u32 v10, s33, v3
    v_mul_u32_u24 v11, 3072, v10
    v_add_u32 v20, v11, v9
    v_add_u32 v21, 23552, v20
    v_add_u32 v22, 47104, v20
    v_add_u32 v23, 70656, v20
    v_lshl_add_u32 v24, v10, 10, v9
    s_lshl_b32 s57, s28, 10
    s_add_u32 s57, s57, 0x400
    s_waitcnt lgkmcnt(0)
    s_mov_b32 s12, s84
    s_mov_b32 s13, s85
    s_mov_b32 s14, 0x180000
    s_mov_b32 s15, 0x20000
    s_load_dword s7, s[94:95], 128
    s_mov_b32 s8, s82
    s_mov_b32 s9, s83
    s_mov_b32 s10, 0x200000
    s_mov_b32 s11, 0x20000
    s_add_u32 m0, s48, 0x0
    s_add_u32 s40, s47, 0
    s_and_b32 s40, s40, 7
    s_mul_i32 s40, s40, 196608
    s_add_u32 s40, s40, s57
    buffer_load_dwordx4 v20, s[12:15], s40 offen offset:0 lds
    buffer_load_dwordx4 v21, s[12:15], s40 offen offset:1024 lds
    buffer_load_dwordx4 v22, s[12:15], s40 offen offset:2048 lds
    buffer_load_dwordx4 v23, s[12:15], s40 offen offset:3072 lds
    s_add_u32 m0, s48, 0x4000
    s_add_u32 s42, s47, 0
    s_and_b32 s42, s42, 7
    s_lshl_b32 s42, s42, 7
    buffer_load_dwordx4 v16, s[8:11], s42 offen offset:0 lds
    buffer_load_dwordx4 v17, s[8:11], s42 offen offset:1024 lds
    buffer_load_dwordx4 v18, s[8:11], s42 offen offset:2048 lds
    buffer_load_dwordx4 v19, s[8:11], s42 offen offset:3072 lds
    s_mov_b32 s16, s86
    s_mov_b32 s17, s87
    s_mov_b32 s18, 0x4000
    s_mov_b32 s19, 0x20000
    v_lshlrev_b32 v7, 4, v1
    s_lshl_b32 s32, s5, 11
    s_lshl_b32 s46, s29, 10
    s_add_u32 s32, s32, s46
    s_lshl_b32 s33, s3, 10
    s_add_u32 m0, s33, 0x20000
    s_nop 0
    buffer_load_dwordx4 v7, s[16:19], s32 offen lds
    s_add_u32 m0, s48, 0x8000
    s_add_u32 s40, s47, 1
    s_and_b32 s40, s40, 7
    s_mul_i32 s40, s40, 196608
    s_add_u32 s40, s40, s57
    buffer_load_dwordx4 v20, s[12:15], s40 offen offset:0 lds
    buffer_load_dwordx4 v21, s[12:15], s40 offen offset:1024 lds
    buffer_load_dwordx4 v22, s[12:15], s40 offen offset:2048 lds
    buffer_load_dwordx4 v23, s[12:15], s40 offen offset:3072 lds
    s_branch L_mainB
L_roleA:
    s_getpc_b64 s[36:37]
L_pcA:
    s_add_u32 s36, s36, L_mainA-L_pcA
    s_addc_u32 s37, s37, 0
    global_load_dword v254, v7, s[36:37]
    v_lshrrev_b32_e64 v9, 1, v3
    v_xor_b32 v9, v9, v4
    v_lshlrev_b32 v9, 4, v9
    v_lshrrev_b32 v10, 2, v3
    v_lshlrev_b32 v10, 5, v10
    v_and_b32 v11, 1, v3
    v_lshl_add_u32 v10, v11, 4, v10
    v_bfe_u32 v11, v3, 1, 1
    v_add_u32 v10, v10, v11
    v_lshl_add_u32 v10, v10, 10, v9
    s_lshl_b32 s32, s4, 17
    s_lshl_b32 s46, s28, 16
    s_add_u32 s32, s32, s46
    s_lshl_b32 s46, s29, 13
    s_add_u32 s32, s32, s46
    v_add_u32 v16, s32, v10
    v_xor_b32 v11, 64, v16
    v_add_u32 v17, 1024, v11
    v_add_u32 v18, 2048, v16
    v_add_u32 v19, 3072, v11
    v_lshl_add_u32 v10, v3, 10, v9
    s_lshl_b32 s32, s5, 16
    s_lshl_b32 s46, s29, 15
    s_add_u32 s32, s32, s46
    v_add_u32_e64 v20, s32, v10
    v_xor_b32 v11, 64, v20
    v_add_u32 v21, 7168, v11
    v_add_u32 v22, 14336, v20
    v_add_u32 v23, 21504, v11
    s_lshl_b32 s32, s5, 7
    s_lshl_b32 s46, s29, 6
    s_add_u32 s32, s32, s46
    v_lshl_add_u32 v14, v5, 1, s32
    s_cmp_eq_u32 s28, 0
    s_waitcnt lgkmcnt(0)
    s_cselect_b32 s12, s70, s72
    s_cselect_b32 s13, s71, s73
    s_cselect_b32 s16, s74, s76
    s_cselect_b32 s17, s75, s77
    s_mov_b32 s14, 0x80000
    s_mov_b32 s15, 0x20000
    s_load_dword s7, s[94:95], 0
    s_mov_b32 s8, s64
    s_mov_b32 s9, s65
    s_mov_b32 s10, 0x200000
    s_mov_b32 s11, 0x20000
    global_load_ushort v224, v14, s[66:67]
    global_load_ushort v225, v14, s[68:69]
    global_load_ushort v226, v14, s[78:79]
    global_load_ushort v222, v14, s[80:81]
    s_add_u32 m0, s48, 0x0
    s_add_u32 s40, s47, 0
    s_and_b32 s40, s40, 7
    s_lshl_b32 s40, s40, 7
    buffer_load_dwordx4 v20, s[12:15], s40 offen offset:0 lds
    buffer_load_dwordx4 v21, s[12:15], s40 offen offset:1024 lds
    buffer_load_dwordx4 v22, s[12:15], s40 offen offset:2048 lds
    buffer_load_dwordx4 v23, s[12:15], s40 offen offset:3072 lds
    s_add_u32 m0, s48, 0x4000
    s_nop 0
    buffer_load_dwordx4 v16, s[8:11], s40 offen offset:0 lds
    buffer_load_dwordx4 v17, s[8:11], s40 offen offset:1024 lds
    buffer_load_dwordx4 v18, s[8:11], s40 offen offset:2048 lds
    buffer_load_dwordx4 v19, s[8:11], s40 offen offset:3072 lds
    s_mov_b32 s18, 0x80000
    s_mov_b32 s19, 0x20000
    s_branch L_mainA
L_mainB:
    s_lshl_b32 s32, s28, 13
    v_bfe_u32 v9, v5, 1, 3
    v_xor_b32 v9, v9, v6
    v_lshlrev_b32 v9, 4, v9
    v_lshl_add_u32 v9, v5, 7, v9
    v_add_u32 v9, s32, v9
    v_add_u32 v9, 0x4000, v9
    v_xor_b32 v28, 0, v9
    v_xor_b32 v29, 32, v9
    v_xor_b32 v30, 64, v9
    v_xor_b32 v31, 96, v9
    v_add_u32 v32, 0x10000, v28
    v_add_u32 v33, 0x10000, v29
    v_add_u32 v34, 0x10000, v30
    v_add_u32 v35, 0x10000, v31
    v_bfe_u32 v9, v1, 4, 1
    v_bfe_u32 v13, v1, 1, 1
    v_lshl_add_u32 v10, v9, 1, v13
    v_bfe_u32 v13, v1, 3, 1
    v_xor_b32 v13, s29, v13
    v_lshl_add_u32 v9, v13, 2, v10
    v_lshlrev_b32_e64 v9, 4, v9
    v_and_b32 v10, 1, v1
    v_lshl_add_u32 v9, v10, 3, v9
    v_bfe_u32 v14, v1, 2, 2
    v_lshl_add_u32 v13, v6, 3, v14
    v_lshl_add_u32 v36, v13, 7, v9
    v_add_u32 v37, 0x10000, v36
    v_add_u32 v38, 0x20000, v36
    s_add_u32 m0, s48, 0xc000
    s_add_u32 s42, s47, 1
    s_and_b32 s42, s42, 7
    s_lshl_b32 s42, s42, 7
    buffer_load_dwordx4 v16, s[8:11], s42 offen offset:0 lds
    buffer_load_dwordx4 v17, s[8:11], s42 offen offset:1024 lds
    buffer_load_dwordx4 v18, s[8:11], s42 offen offset:2048 lds
    buffer_load_dwordx4 v19, s[8:11], s42 offen offset:3072 lds
    s_add_u32 m0, s48, 0x10000
    s_add_u32 s40, s47, 2
    s_and_b32 s40, s40, 7
    s_mul_i32 s40, s40, 196608
    s_add_u32 s40, s40, s57
    buffer_load_dwordx4 v20, s[12:15], s40 offen offset:0 lds
    buffer_load_dwordx4 v21, s[12:15], s40 offen offset:1024 lds
    buffer_load_dwordx4 v22, s[12:15], s40 offen offset:2048 lds
    buffer_load_dwordx4 v23, s[12:15], s40 offen offset:3072 lds
    s_add_u32 m0, s48, 0x14000
    s_add_u32 s42, s47, 2
    s_and_b32 s42, s42, 7
    s_lshl_b32 s42, s42, 7
    buffer_load_dwordx4 v16, s[8:11], s42 offen offset:0 lds
    buffer_load_dwordx4 v17, s[8:11], s42 offen offset:1024 lds
    buffer_load_dwordx4 v18, s[8:11], s42 offen offset:2048 lds
    buffer_load_dwordx4 v19, s[8:11], s42 offen offset:3072 lds
    s_waitcnt vmcnt(17)
    s_barrier
    ds_read_b128 a[0:3], v28 offset:0
    ds_read_b64_tr_b16 v[48:49], v36 offset:0
    ds_read_b64_tr_b16 v[50:51], v36 offset:512
    ds_read_b128 a[4:7], v28 offset:4096
    ds_read_b64_tr_b16 v[52:53], v36 offset:8192
    ds_read_b64_tr_b16 v[54:55], v36 offset:8704
    s_waitcnt lgkmcnt(0)
    v_mfma_f32_32x32x16_bf16 v[64:79], v[48:51], a[0:3], 0
    ds_read_b128 a[8:11], v29 offset:0
    ds_read_b64_tr_b16 v[56:57], v36 offset:2048
    ds_read_b64_tr_b16 v[58:59], v36 offset:2560
    s_mov_b32 s16, s88
    s_mov_b32 s17, s89
    s_mov_b32 s18, 0x80000
    s_mov_b32 s19, 0x20000
    s_mov_b32 s20, s94
    s_mov_b32 s21, s95
    s_mov_b32 s22, 0x10000000
    s_mov_b32 s23, 0x20000
    s_mov_b32 s24, s90
    s_mov_b32 s25, s91
    v_mfma_f32_32x32x16_bf16 v[80:95], v[48:51], a[4:7], 0
    ds_read_b128 a[12:15], v29 offset:4096
    ds_read_b64_tr_b16 v[60:61], v36 offset:10240
    ds_read_b64_tr_b16 v[62:63], v36 offset:10752
    s_mov_b32 s26, 0x800000
    s_mov_b32 s27, 0x20000
    s_lshl_b32 s49, s3, 13
    s_mov_b32 s50, 0
    s_mov_b32 s51, -1
    s_sub_u32 s52, 0, s28
    s_mov_b32 s53, s52
    s_mov_b32 s54, 0x3fb8aa3b
    s_mov_b32 s55, 0x3fb8aa3b
    s_mov_b32 s60, 0xffff0000
    v_mfma_f32_32x32x16_bf16 v[96:111], a[0:3], v[52:55], 0
    s_add_u32 m0, s48, 0x18000
    s_add_u32 s40, s47, 3
    s_and_b32 s40, s40, 7
    s_mul_i32 s40, s40, 196608
    s_add_u32 s40, s40, s57
    buffer_load_dwordx4 v20, s[12:15], s40 offen offset:0 lds
    s_mov_b32 s61, 0xffff0000
    s_add_u32 s31, s4, 16
    s_lshl_b32 s66, s31, 10
    s_add_u32 s66, s66, 0x8000
    s_and_b32 s90, s5, 1
    s_lshl_b32 s68, s4, 19
    s_lshl_b32 s46, s28, 18
    s_add_u32 s68, s68, s46
    s_lshl_b32 s46, s5, 8
    s_add_u32 s68, s68, s46
    v_mfma_f32_32x32x16_bf16 v[112:127], a[4:7], v[52:55], 0
    buffer_load_dwordx4 v21, s[12:15], s40 offen offset:1024 lds
    s_lshl_b32 s46, s29, 7
    s_add_u32 s68, s68, s46
    s_lshl_b32 s46, s90, 17
    s_add_u32 s68, s68, s46
    s_add_u32 s68, s68, 0x800
    s_xor_b32 s69, s68, 0x20000
    s_lshl_b32 s67, s4, 8
    s_lshl_b32 s46, s5, 4
    s_add_u32 s67, s67, s46
    s_add_u32 s67, s67, s3
    s_waitcnt lgkmcnt(0)
    v_mfma_f32_32x32x16_bf16 v[64:79], v[56:59], a[8:11], v[64:79]
    ds_read_b128 a[16:19], v30 offset:0
    ds_read_b64_tr_b16 v[48:49], v36 offset:4096
    ds_read_b64_tr_b16 v[50:51], v36 offset:4608
    s_and_b32 s32, s4, 3
    s_lshl_b32 s32, s32, 1
    s_mov_b32 s62, s5
    s_add_u32 s33, s32, 0
    s_cmp_ge_u32 s33, 7
    s_addc_u32 s33, s33, 1
    s_add_u32 s33, s33, s5
    s_and_b32 s63, s33, 7
    s_add_u32 s33, s32, 1
    s_cmp_ge_u32 s33, 7
    s_addc_u32 s33, s33, 1
    v_mfma_f32_32x32x16_bf16 v[80:95], v[56:59], a[12:15], v[80:95]
    ds_read_b128 a[20:23], v30 offset:4096
    ds_read_b64_tr_b16 v[52:53], v36 offset:12288
    ds_read_b64_tr_b16 v[54:55], v36 offset:12800
    s_add_u32 s33, s33, s5
    s_and_b32 s44, s33, 7
    s_add_u32 s33, s32, 2
    s_cmp_ge_u32 s33, 7
    s_addc_u32 s33, s33, 1
    s_add_u32 s33, s33, s5
    s_and_b32 s45, s33, 7
    s_add_u32 s33, s32, 3
    s_cmp_ge_u32 s33, 7
    s_addc_u32 s33, s33, 1
    v_mfma_f32_32x32x16_bf16 v[96:111], a[8:11], v[60:63], v[96:111]
    buffer_load_dwordx4 v22, s[12:15], s40 offen offset:2048 lds
    s_add_u32 s33, s33, s5
    s_and_b32 s86, s33, 7
    s_add_u32 s33, s32, 4
    s_cmp_ge_u32 s33, 7
    s_addc_u32 s33, s33, 1
    s_add_u32 s33, s33, s5
    s_and_b32 s87, s33, 7
    s_add_u32 s33, s32, 5
    s_cmp_ge_u32 s33, 7
    s_addc_u32 s33, s33, 1
    v_mfma_f32_32x32x16_bf16 v[112:127], a[12:15], v[60:63], v[112:127]
    buffer_load_dwordx4 v23, s[12:15], s40 offen offset:3072 lds
    s_add_u32 s33, s33, s5
    s_and_b32 s94, s33, 7
    s_add_u32 s33, s32, 6
    s_cmp_ge_u32 s33, 7
    s_addc_u32 s33, s33, 1
    s_add_u32 s33, s33, s5
    s_and_b32 s95, s33, 7
    v_lshlrev_b32_e64 v7, 4, v1
    v_mov_b32 v10, 0x40000000
    v_cmp_eq_u32 vcc, 0, v1
    s_waitcnt lgkmcnt(0)
    v_mfma_f32_32x32x16_bf16 v[64:79], v[48:51], a[16:19], v[64:79]
    ds_read_b128 a[24:27], v31 offset:0
    ds_read_b64_tr_b16 v[56:57], v36 offset:6144
    ds_read_b64_tr_b16 v[58:59], v36 offset:6656
    v_lshlrev_b32 v12, 2, v5
    s_lshl_b32 s64, s31, 8
    s_add_u32 s64, s64, 0x2000
    s_lshl_b32 s93, s5, 4
    s_lshl_b32 s46, s3, 2
    s_add_u32 s93, s93, s46
    s_add_u32 s93, s93, s64
    s_getreg_b32 s91, hwreg(HW_REG_XCC_ID, 0, 4)
    v_lshlrev_b32 v15, 7, v4
    v_cndmask_b32_e64 v10, v10, 0, vcc
    v_mfma_f32_32x32x16_bf16 v[80:95], v[48:51], a[20:23], v[80:95]
    ds_read_b128 a[28:31], v31 offset:4096
    ds_read_b64_tr_b16 v[60:61], v36 offset:14336
    ds_read_b64_tr_b16 v[62:63], v36 offset:14848
    v_lshlrev_b32 v2, 14, v6
    v_lshl_add_u32 v2, v5, 2, v2
    s_lshl_b32 s65, s5, 7
    s_add_u32 s65, s65, s66
    s_add_u32 s7, s7, 1
    s_lshl_b32 s32, s7, 4
    s_or_b32 s91, s91, s32
    v_mov_b32_e64 v248, s91
    v_mov_b32 v249, 0x40000000
    v_cmp_gt_u32 vcc, 32, v0
    v_mfma_f32_32x32x16_bf16 v[96:111], a[16:19], v[52:55], v[96:111]
    s_add_u32 m0, s48, 0x1c000
    s_add_u32 s42, s47, 3
    s_and_b32 s42, s42, 7
    s_lshl_b32 s42, s42, 7
    buffer_load_dwordx4 v16, s[8:11], s42 offen offset:0 lds
    v_cndmask_b32 v249, v249, v12, vcc
    v_add_u32 v25, 7168, v24
    v_add_u32 v26, 14336, v24
    v_add_u32 v27, 21504, v24
    v_bfe_u32 v9, v1, 4, 1
    v_bfe_u32 v13, v1, 1, 1
    v_lshl_add_u32 v9, v9, 1, v13
    v_lshlrev_b32_e64 v9, 3, v9
    v_bfe_u32 v13, v1, 2, 2
    v_lshl_add_u32 v13, v6, 2, v13
    v_mfma_f32_32x32x16_bf16 v[112:127], a[20:23], v[52:55], v[112:127]
    buffer_load_dwordx4 v17, s[8:11], s42 offen offset:1024 lds
    v_lshl_add_u32 v9, v13, 5, v9
    s_lshl_b32 s32, s3, 10
    s_add_u32 s32, s32, 0x20000
    v_add_u32 v252, s32, v9
    s_lshl_b32 s32, s5, 8
    s_lshl_b32 s46, s29, 7
    s_add_u32 s32, s32, s46
    s_lshl_b32 s46, s28, 5
    s_add_u32 s32, s32, s46
    s_add_u32 s32, s32, s4
    s_waitcnt vmcnt(14) lgkmcnt(0)
    v_mfma_f32_32x32x16_bf16 v[64:79], v[56:59], a[24:27], v[64:79]
    s_barrier
    ds_read_b128 a[32:35], v28 offset:32768
    ds_read_b64_tr_b16 v[48:49], v36 offset:32768
    ds_read_b64_tr_b16 v[50:51], v36 offset:33280
    s_mul_i32 s73, s32, 640
    s_add_u32 s73, s73, 0x100000
    s_lshl_b32 s32, s5, 4
    s_add_u32 s32, s32, s4
    s_mul_i32 s80, s32, 640
    s_add_u32 s80, s80, 0x3c0000
    s_mul_i32 s74, s32, 10240
    s_add_u32 s74, s74, 0x100000
    s_add_u32 s75, s74, 5120
    s_add_u32 s76, s74, 10240
    v_mfma_f32_32x32x16_bf16 v[80:95], v[56:59], a[28:31], v[80:95]
    ds_read_b128 a[36:39], v28 offset:36864
    ds_read_b64_tr_b16 v[52:53], v36 offset:40960
    ds_read_b64_tr_b16 v[54:55], v36 offset:41472
    s_add_u32 s77, s74, 15360
    s_lshl_b32 s32, s5, 4
    s_lshl_b32 s46, s29, 3
    s_add_u32 s32, s32, s46
    s_mul_i32 s81, s32, 640
    s_add_u32 s81, s81, 0x3c0000
    s_mov_b32 s82, 0xffffff00
    s_lshl_b32 s88, s4, 17
    s_lshl_b32 s46, s5, 14
    s_add_u32 s88, s88, s46
    v_mfma_f32_32x32x16_bf16 v[96:111], a[24:27], v[60:63], v[96:111]
    buffer_load_dwordx4 v18, s[8:11], s42 offen offset:2048 lds
    s_lshl_b32 s46, s28, 12
    s_add_u32 s88, s88, s46
    s_lshl_b32 s46, s29, 11
    s_add_u32 s88, s88, s46
    s_add_u32 s88, s88, 0x800000
    s_add_u32 s89, s88, 8192
    s_lshl_b32 s70, s4, 17
    s_lshl_b32 s46, s90, 13
    s_add_u32 s70, s70, s46
    s_lshl_b32 s46, s3, 11
    v_mfma_f32_32x32x16_bf16 v[112:127], a[28:31], v[60:63], v[112:127]
    buffer_load_dwordx4 v19, s[8:11], s42 offen offset:3072 lds
    s_add_u32 s70, s70, s46
    s_add_u32 s70, s70, 0x800000
    s_lshl_b32 s49, s3, 11
    s_xor_b32 s71, s70, 8192
    s_and_b32 s32, s7, 0xff
    v_mov_b32 v8, s32
    v_mov_b32 v11, s7
    v_and_b32 v9, 1, v5
    v_lshlrev_b32 v9, 4, v9
    v_mov_b32 v13, 0x3f80
    s_waitcnt lgkmcnt(0)
    v_mfma_f32_32x32x16_bf16 v[64:79], v[48:51], a[32:35], v[64:79]
    ds_read_b128 a[40:43], v29 offset:32768
    ds_read_b64_tr_b16 v[56:57], v36 offset:34816
    ds_read_b64_tr_b16 v[58:59], v36 offset:35328
    v_lshlrev_b32 v13, v9, v13
    v_lshrrev_b32 v9, 1, v5
    v_lshlrev_b32 v14, 3, v6
    v_sub_u32 v9, v9, v14
    v_cmp_eq_u32 vcc, 0, v9
    s_nop 1
    v_cndmask_b32_e64 v240, 0, v13, vcc
    v_cmp_eq_u32 vcc, 1, v9
    s_nop 1
    v_cndmask_b32_e64 v241, 0, v13, vcc
    v_cmp_eq_u32_e64 vcc, 2, v9
    s_nop 1
    v_cndmask_b32_e64 v242, 0, v13, vcc
    v_mfma_f32_32x32x16_bf16 v[80:95], v[48:51], a[36:39], v[80:95]
    ds_read_b128 a[44:47], v29 offset:36864
    ds_read_b64_tr_b16 v[60:61], v36 offset:43008
    ds_read_b64_tr_b16 v[62:63], v36 offset:43520
    v_cmp_eq_u32 vcc, 3, v9
    s_nop 1
    v_cndmask_b32_e64 v243, 0, v13, vcc
    v_cmp_eq_u32 vcc, 4, v9
    s_nop 1
    v_cndmask_b32_e64 v244, 0, v13, vcc
    v_cmp_eq_u32 vcc, 5, v9
    s_nop 1
    v_cndmask_b32_e64 v245, 0, v13, vcc
    v_cmp_eq_u32 vcc, 6, v9
    s_nop 1
    v_cndmask_b32_e64 v246, 0, v13, vcc
    v_cmp_eq_u32 vcc, 7, v9
    s_nop 1
    v_cndmask_b32_e64 v247, 0, v13, vcc
    v_mfma_f32_32x32x16_bf16 v[96:111], a[32:35], v[52:55], v[96:111]
    s_add_u32 m0, s48, 0x0
    s_add_u32 s40, s47, 4
    s_and_b32 s40, s40, 7
    s_mul_i32 s40, s40, 196608
    s_add_u32 s40, s40, s57
    buffer_load_dwordx4 v20, s[12:15], s40 offen offset:0 lds
    v_and_b32_e64 v9, 15, v1
    v_cmp_gt_u32 vcc, 4, v9
    v_lshlrev_b32 v9, 4, v9
    v_lshl_add_u32 v13, v6, 6, v9
    v_add_u32 v13, 512, v13
    v_lshl_add_u32 v9, v6, 8, v9
    v_mov_b32 v14, 0x40000000
    v_cndmask_b32 v13, v14, v13, vcc
    v_cndmask_b32_e64 v43, v9, v13, s[60:61]
    v_cndmask_b32_e64 v44, v13, v9, s[60:61]
    v_mfma_f32_32x32x16_bf16 v[112:127], a[36:39], v[52:55], v[112:127]
    buffer_load_dwordx4 v21, s[12:15], s40 offen offset:1024 lds
    v_cndmask_b32_e64 v13, v13, v14, s[60:61]
    s_cmp_eq_u32 s3, 0
    s_cselect_b64 vcc, -1, 0
    v_cndmask_b32 v253, v14, v13, vcc
    v_and_b32 v9, 7, v1
    s_lshl_b32 s32, s3, 7
    v_lshl_add_u32 v9, v9, 4, s32
    v_lshrrev_b32 v13, 3, v1
    v_mul_u32_u24 v13, 640, v13
    v_add_u32 v45, v9, v13
    s_waitcnt lgkmcnt(0)
    v_mfma_f32_32x32x16_bf16 v[64:79], v[56:59], a[40:43], v[64:79]
    ds_read_b128 a[48:51], v30 offset:32768
    ds_read_b64_tr_b16 v[48:49], v36 offset:36864
    ds_read_b64_tr_b16 v[50:51], v36 offset:37376
    v_cmp_gt_u32 vcc, 8, v1
    v_and_b32 v13, 15, v5
    v_mul_u32_u24 v46, 640, v13
    s_lshl_b32 s32, s3, 12
    s_add_u32 s32, s32, 0x18000
    v_add_u32 v39, s32, v7
    v_xor_b32 v40, 0x2000, v39
    v_lshl_add_u32 v46, v6, 6, v46
    v_cndmask_b32 v41, v14, v9, vcc
    v_bfe_u32 v9, v5, 2, 1
    v_mfma_f32_32x32x16_bf16 v[80:95], v[56:59], a[44:47], v[80:95]
    ds_read_b128 a[52:55], v30 offset:36864
    ds_read_b64_tr_b16 v[52:53], v36 offset:45056
    ds_read_b64_tr_b16 v[54:55], v36 offset:45568
    v_lshlrev_b32 v9, 3, v9
    v_bfe_u32 v13, v5, 3, 1
    v_lshl_add_u32 v9, v13, 2, v9
    v_and_b32 v13, 3, v5
    v_add_u32 v9, v9, v13
    v_cndmask_b32_e64 v9, v9, 32, s[60:61]
    v_lshlrev_b32 v9, 4, v9
    v_mul_u32_u24 v13, 1280, v6
    v_add_u32 v47, v9, v13
    v_mov_b32 v9, 0x100
    v_mfma_f32_32x32x16_bf16 v[96:111], a[40:43], v[60:63], v[96:111]
    buffer_load_dwordx4 v22, s[12:15], s40 offen offset:2048 lds
    v_mov_b32 v13, 64
    v_cndmask_b32_e64 v9, v9, v13, s[60:61]
    v_add_u32 v42, v47, v9
    v_subrev_u32 v236, 1, v8
    v_subrev_u32 v237, 1, v8
    v_subrev_u32 v238, 1, v8
    v_subrev_u32 v239, 1, v8
    v_mov_b32 v3, 0x3f803f80
    v_bfe_u32 v4, v1, 2, 1
    v_mul_u32_u24 v4, 0x8000, v4
    v_mfma_f32_32x32x16_bf16 v[112:127], a[44:47], v[60:63], v[112:127]
    buffer_load_dwordx4 v23, s[12:15], s40 offen offset:3072 lds
    v_lshl_or_b32 v4, v4, 16, v4
    s_waitcnt lgkmcnt(0)
    v_mfma_f32_32x32x16_bf16 v[64:79], v[48:51], a[48:51], v[64:79]
    ds_read_b128 a[56:59], v31 offset:32768
    ds_read_b64_tr_b16 v[56:57], v36 offset:38912
    ds_read_b64_tr_b16 v[58:59], v36 offset:39424
    v_mfma_f32_32x32x16_bf16 v[80:95], v[48:51], a[52:55], v[80:95]
    ds_read_b128 a[60:63], v31 offset:36864
    ds_read_b64_tr_b16 v[60:61], v36 offset:47104
    ds_read_b64_tr_b16 v[62:63], v36 offset:47616
    v_mfma_f32_32x32x16_bf16 v[96:111], a[48:51], v[52:55], v[96:111]
    s_add_u32 m0, s48, 0x4000
    s_add_u32 s42, s47, 4
    s_and_b32 s42, s42, 7
    s_lshl_b32 s42, s42, 7
    buffer_load_dwordx4 v16, s[8:11], s42 offen offset:0 lds
    v_mfma_f32_32x32x16_bf16 v[112:127], a[52:55], v[52:55], v[112:127]
    buffer_load_dwordx4 v17, s[8:11], s42 offen offset:1024 lds
    s_waitcnt vmcnt(14) lgkmcnt(0)
    v_mfma_f32_32x32x16_bf16 v[64:79], v[56:59], a[56:59], v[64:79]
    s_barrier
    ds_read_b128 a[64:67], v32 offset:0
    ds_read_b64_tr_b16 v[48:49], v37 offset:0
    ds_read_b64_tr_b16 v[50:51], v37 offset:512
    v_mfma_f32_32x32x16_bf16 v[80:95], v[56:59], a[60:63], v[80:95]
    ds_read_b128 a[68:71], v32 offset:4096
    ds_read_b64_tr_b16 v[52:53], v37 offset:8192
    ds_read_b64_tr_b16 v[54:55], v37 offset:8704
    v_mfma_f32_32x32x16_bf16 v[96:111], a[56:59], v[60:63], v[96:111]
    buffer_load_dwordx4 v18, s[8:11], s42 offen offset:2048 lds
    ds_read_b64_tr_b16 v[224:225], v252 offset:0
    ds_read_b64_tr_b16 v[226:227], v252 offset:256
    v_mfma_f32_32x32x16_bf16 v[112:127], a[60:63], v[60:63], v[112:127]
    buffer_load_dwordx4 v19, s[8:11], s42 offen offset:3072 lds
    s_waitcnt lgkmcnt(0)
    v_mfma_f32_32x32x16_bf16 v[64:79], v[48:51], a[64:67], v[64:79]
    ds_read_b128 a[72:75], v33 offset:0
    ds_read_b64_tr_b16 v[56:57], v37 offset:2048
    ds_read_b64_tr_b16 v[58:59], v37 offset:2560
    v_mfma_f32_32x32x16_bf16 v[80:95], v[48:51], a[68:71], v[80:95]
    ds_read_b128 a[76:79], v33 offset:4096
    ds_read_b64_tr_b16 v[60:61], v37 offset:10240
    ds_read_b64_tr_b16 v[62:63], v37 offset:10752
    v_mfma_f32_32x32x16_bf16 v[96:111], a[64:67], v[52:55], v[96:111]
    s_add_u32 m0, s48, 0x8000
    s_add_u32 s40, s47, 5
    s_and_b32 s40, s40, 7
    s_mul_i32 s40, s40, 196608
    s_add_u32 s40, s40, s57
    buffer_load_dwordx4 v20, s[12:15], s40 offen offset:0 lds
    ds_read_b64_tr_b16 v[228:229], v252 offset:512
    ds_read_b64_tr_b16 v[230:231], v252 offset:768
    v_mfma_f32_32x32x16_bf16 v[112:127], a[68:71], v[52:55], v[112:127]
    buffer_load_dwordx4 v21, s[12:15], s40 offen offset:1024 lds
    s_waitcnt lgkmcnt(0)
    s_nop 0
    v_mfma_f32_32x32x16_bf16 v[64:79], v[56:59], a[72:75], v[64:79]
    ds_read_b128 a[80:83], v34 offset:0
    ds_read_b64_tr_b16 v[48:49], v37 offset:4096
    ds_read_b64_tr_b16 v[50:51], v37 offset:4608
    v_mfma_f32_32x32x16_bf16 v[80:95], v[56:59], a[76:79], v[80:95]
    ds_read_b128 a[84:87], v34 offset:4096
    ds_read_b64_tr_b16 v[52:53], v37 offset:12288
    ds_read_b64_tr_b16 v[54:55], v37 offset:12800
    v_mfma_f32_32x32x16_bf16 v[96:111], a[72:75], v[60:63], v[96:111]
    buffer_load_dwordx4 v22, s[12:15], s40 offen offset:2048 lds
    v_mfma_f32_32x32x16_bf16 v[112:127], a[76:79], v[60:63], v[112:127]
    buffer_load_dwordx4 v23, s[12:15], s40 offen offset:3072 lds
    s_waitcnt lgkmcnt(0)
    v_mfma_f32_32x32x16_bf16 v[64:79], v[48:51], a[80:83], v[64:79]
    ds_read_b128 a[88:91], v35 offset:0
    ds_read_b64_tr_b16 v[56:57], v37 offset:6144
    ds_read_b64_tr_b16 v[58:59], v37 offset:6656
    v_mfma_f32_32x32x16_bf16 v[80:95], v[48:51], a[84:87], v[80:95]
    ds_read_b128 a[92:95], v35 offset:4096
    ds_read_b64_tr_b16 v[60:61], v37 offset:14336
    ds_read_b64_tr_b16 v[62:63], v37 offset:14848
    v_mfma_f32_32x32x16_bf16 v[96:111], a[80:83], v[52:55], v[96:111]
    s_add_u32 m0, s48, 0xc000
    s_add_u32 s42, s47, 5
    s_and_b32 s42, s42, 7
    s_lshl_b32 s42, s42, 7
    buffer_load_dwordx4 v16, s[8:11], s42 offen offset:0 lds
    v_mfma_f32_32x32x16_bf16 v[112:127], a[84:87], v[52:55], v[112:127]
    buffer_load_dwordx4 v17, s[8:11], s42 offen offset:1024 lds
    s_waitcnt vmcnt(14) lgkmcnt(0)
    v_mfma_f32_32x32x16_bf16 v[64:79], v[56:59], a[88:91], v[64:79]
    s_barrier
    ds_read_b128 a[96:99], v32 offset:32768
    ds_read_b64_tr_b16 v[48:49], v37 offset:32768
    ds_read_b64_tr_b16 v[50:51], v37 offset:33280
    v_mfma_f32_32x32x16_bf16 v[80:95], v[56:59], a[92:95], v[80:95]
    ds_read_b128 a[100:103], v32 offset:36864
    ds_read_b64_tr_b16 v[52:53], v37 offset:40960
    ds_read_b64_tr_b16 v[54:55], v37 offset:41472
    v_mfma_f32_32x32x16_bf16 v[96:111], a[88:91], v[60:63], v[96:111]
    buffer_load_dwordx4 v18, s[8:11], s42 offen offset:2048 lds
    v_mfma_f32_32x32x16_bf16 v[112:127], a[92:95], v[60:63], v[112:127]
    buffer_load_dwordx4 v19, s[8:11], s42 offen offset:3072 lds
    s_waitcnt lgkmcnt(0)
    v_mfma_f32_32x32x16_bf16 v[64:79], v[48:51], a[96:99], v[64:79]
    ds_read_b128 a[104:107], v33 offset:32768
    ds_read_b64_tr_b16 v[56:57], v37 offset:34816
    ds_read_b64_tr_b16 v[58:59], v37 offset:35328
    v_mfma_f32_32x32x16_bf16 v[80:95], v[48:51], a[100:103], v[80:95]
    ds_read_b128 a[108:111], v33 offset:36864
    ds_read_b64_tr_b16 v[60:61], v37 offset:43008
    ds_read_b64_tr_b16 v[62:63], v37 offset:43520
    v_mfma_f32_32x32x16_bf16 v[96:111], a[96:99], v[52:55], v[96:111]
    s_add_u32 m0, s48, 0x10000
    s_add_u32 s40, s47, 6
    s_and_b32 s40, s40, 7
    s_mul_i32 s40, s40, 196608
    s_add_u32 s40, s40, s57
    buffer_load_dwordx4 v20, s[12:15], s40 offen offset:0 lds
    v_mfma_f32_32x32x16_bf16 v[112:127], a[100:103], v[52:55], v[112:127]
    buffer_load_dwordx4 v21, s[12:15], s40 offen offset:1024 lds
    s_waitcnt lgkmcnt(0)
    s_nop 0
    v_mfma_f32_32x32x16_bf16 v[64:79], v[56:59], a[104:107], v[64:79]
    ds_read_b128 a[112:115], v34 offset:32768
    ds_read_b64_tr_b16 v[48:49], v37 offset:36864
    ds_read_b64_tr_b16 v[50:51], v37 offset:37376
    v_mfma_f32_32x32x16_bf16 v[80:95], v[56:59], a[108:111], v[80:95]
    ds_read_b128 a[116:119], v34 offset:36864
    ds_read_b64_tr_b16 v[52:53], v37 offset:45056
    ds_read_b64_tr_b16 v[54:55], v37 offset:45568
    v_mfma_f32_32x32x16_bf16 v[96:111], a[104:107], v[60:63], v[96:111]
    buffer_load_dwordx4 v22, s[12:15], s40 offen offset:2048 lds
    v_mfma_f32_32x32x16_bf16 v[112:127], a[108:111], v[60:63], v[112:127]
    buffer_load_dwordx4 v23, s[12:15], s40 offen offset:3072 lds
    s_waitcnt lgkmcnt(0)
    v_mfma_f32_32x32x16_bf16 v[64:79], v[48:51], a[112:115], v[64:79]
    ds_read_b128 a[120:123], v35 offset:32768
    ds_read_b64_tr_b16 v[56:57], v37 offset:38912
    ds_read_b64_tr_b16 v[58:59], v37 offset:39424
    v_mfma_f32_32x32x16_bf16 v[80:95], v[48:51], a[116:119], v[80:95]
    ds_read_b128 a[124:127], v35 offset:36864
    ds_read_b64_tr_b16 v[60:61], v37 offset:47104
    ds_read_b64_tr_b16 v[62:63], v37 offset:47616
    v_mfma_f32_32x32x16_bf16 v[96:111], a[112:115], v[52:55], v[96:111]
    s_add_u32 m0, s48, 0x14000
    s_add_u32 s42, s47, 6
    s_and_b32 s42, s42, 7
    s_lshl_b32 s42, s42, 7
    buffer_load_dwordx4 v16, s[8:11], s42 offen offset:0 lds
    v_mfma_f32_32x32x16_bf16 v[112:127], a[116:119], v[52:55], v[112:127]
    buffer_load_dwordx4 v17, s[8:11], s42 offen offset:1024 lds
    s_waitcnt vmcnt(14) lgkmcnt(0)
    v_mfma_f32_32x32x16_bf16 v[64:79], v[56:59], a[120:123], v[64:79]
    s_barrier
    ds_read_b128 a[128:131], v28 offset:0
    ds_read_b64_tr_b16 v[48:49], v36 offset:0
    ds_read_b64_tr_b16 v[50:51], v36 offset:512
    v_mfma_f32_32x32x16_bf16 v[80:95], v[56:59], a[124:127], v[80:95]
    ds_read_b128 a[132:135], v28 offset:4096
    ds_read_b64_tr_b16 v[52:53], v36 offset:8192
    ds_read_b64_tr_b16 v[54:55], v36 offset:8704
    v_mfma_f32_32x32x16_bf16 v[96:111], a[120:123], v[60:63], v[96:111]
    buffer_load_dwordx4 v18, s[8:11], s42 offen offset:2048 lds
    v_mfma_f32_32x32x16_bf16 v[112:127], a[124:127], v[60:63], v[112:127]
    buffer_load_dwordx4 v19, s[8:11], s42 offen offset:3072 lds
    s_waitcnt lgkmcnt(0)
    v_mfma_f32_32x32x16_bf16 v[64:79], v[48:51], a[128:131], v[64:79]
    ds_read_b128 a[136:139], v29 offset:0
    ds_read_b64_tr_b16 v[56:57], v36 offset:2048
    ds_read_b64_tr_b16 v[58:59], v36 offset:2560
    v_mfma_f32_32x32x16_bf16 v[80:95], v[48:51], a[132:135], v[80:95]
    ds_read_b128 a[140:143], v29 offset:4096
    ds_read_b64_tr_b16 v[60:61], v36 offset:10240
    ds_read_b64_tr_b16 v[62:63], v36 offset:10752
    v_mfma_f32_32x32x16_bf16 v[96:111], a[128:131], v[52:55], v[96:111]
    s_add_u32 m0, s48, 0x18000
    s_add_u32 s40, s47, 7
    s_and_b32 s40, s40, 7
    s_mul_i32 s40, s40, 196608
    s_add_u32 s40, s40, s57
    buffer_load_dwordx4 v20, s[12:15], s40 offen offset:0 lds
    v_mfma_f32_32x32x16_bf16 v[112:127], a[132:135], v[52:55], v[112:127]
    buffer_load_dwordx4 v21, s[12:15], s40 offen offset:1024 lds
    s_waitcnt lgkmcnt(0)
    s_nop 0
    v_mfma_f32_32x32x16_bf16 v[64:79], v[56:59], a[136:139], v[64:79]
    ds_read_b128 a[144:147], v30 offset:0
    ds_read_b64_tr_b16 v[48:49], v36 offset:4096
    ds_read_b64_tr_b16 v[50:51], v36 offset:4608
    v_mfma_f32_32x32x16_bf16 v[80:95], v[56:59], a[140:143], v[80:95]
    ds_read_b128 a[148:151], v30 offset:4096
    ds_read_b64_tr_b16 v[52:53], v36 offset:12288
    ds_read_b64_tr_b16 v[54:55], v36 offset:12800
    v_mfma_f32_32x32x16_bf16 v[96:111], a[136:139], v[60:63], v[96:111]
    buffer_load_dwordx4 v22, s[12:15], s40 offen offset:2048 lds
    v_mfma_f32_32x32x16_bf16 v[112:127], a[140:143], v[60:63], v[112:127]
    buffer_load_dwordx4 v23, s[12:15], s40 offen offset:3072 lds
    s_waitcnt lgkmcnt(0)
    v_mfma_f32_32x32x16_bf16 v[64:79], v[48:51], a[144:147], v[64:79]
    ds_read_b128 a[152:155], v31 offset:0
    ds_read_b64_tr_b16 v[56:57], v36 offset:6144
    ds_read_b64_tr_b16 v[58:59], v36 offset:6656
    v_mfma_f32_32x32x16_bf16 v[80:95], v[48:51], a[148:151], v[80:95]
    ds_read_b128 a[156:159], v31 offset:4096
    ds_read_b64_tr_b16 v[60:61], v36 offset:14336
    ds_read_b64_tr_b16 v[62:63], v36 offset:14848
    v_mfma_f32_32x32x16_bf16 v[96:111], a[144:147], v[52:55], v[96:111]
    s_add_u32 m0, s48, 0x1c000
    s_add_u32 s42, s47, 7
    s_and_b32 s42, s42, 7
    s_lshl_b32 s42, s42, 7
    buffer_load_dwordx4 v16, s[8:11], s42 offen offset:0 lds
    v_mfma_f32_32x32x16_bf16 v[112:127], a[148:151], v[52:55], v[112:127]
    buffer_load_dwordx4 v17, s[8:11], s42 offen offset:1024 lds
    s_waitcnt vmcnt(14) lgkmcnt(0)
    v_mfma_f32_32x32x16_bf16 v[64:79], v[56:59], a[152:155], v[64:79]
    s_barrier
    ds_read_b128 a[160:163], v28 offset:32768
    ds_read_b64_tr_b16 v[48:49], v36 offset:32768
    ds_read_b64_tr_b16 v[50:51], v36 offset:33280
    v_mfma_f32_32x32x16_bf16 v[80:95], v[56:59], a[156:159], v[80:95]
    ds_read_b128 a[164:167], v28 offset:36864
    ds_read_b64_tr_b16 v[52:53], v36 offset:40960
    ds_read_b64_tr_b16 v[54:55], v36 offset:41472
    v_mfma_f32_32x32x16_bf16 v[96:111], a[152:155], v[60:63], v[96:111]
    buffer_load_dwordx4 v18, s[8:11], s42 offen offset:2048 lds
    v_mfma_f32_32x32x16_bf16 v[112:127], a[156:159], v[60:63], v[112:127]
    buffer_load_dwordx4 v19, s[8:11], s42 offen offset:3072 lds
    s_waitcnt lgkmcnt(0)
    v_mfma_f32_32x32x16_bf16 v[64:79], v[48:51], a[160:163], v[64:79]
    ds_read_b128 a[168:171], v29 offset:32768
    ds_read_b64_tr_b16 v[56:57], v36 offset:34816
    ds_read_b64_tr_b16 v[58:59], v36 offset:35328
    v_mfma_f32_32x32x16_bf16 v[80:95], v[48:51], a[164:167], v[80:95]
    ds_read_b128 a[172:175], v29 offset:36864
    ds_read_b64_tr_b16 v[60:61], v36 offset:43008
    ds_read_b64_tr_b16 v[62:63], v36 offset:43520
    v_mfma_f32_32x32x16_bf16 v[96:111], a[160:163], v[52:55], v[96:111]
    s_add_u32 m0, s48, 0x20000
    s_add_u32 s41, s47, 0
    s_add_u32 s41, s41, s28
    s_and_b32 s41, s41, 7
    s_mul_i32 s41, s41, 196608
    buffer_load_dwordx4 v20, s[12:15], s41 offen offset:0 lds
    v_mfma_f32_32x32x16_bf16 v[112:127], a[164:167], v[52:55], v[112:127]
    buffer_load_dwordx4 v21, s[12:15], s41 offen offset:1024 lds
    s_waitcnt lgkmcnt(0)
    s_nop 0
    v_mfma_f32_32x32x16_bf16 v[64:79], v[56:59], a[168:171], v[64:79]
    ds_read_b128 a[176:179], v30 offset:32768
    ds_read_b64_tr_b16 v[48:49], v36 offset:36864
    ds_read_b64_tr_b16 v[50:51], v36 offset:37376
    v_mfma_f32_32x32x16_bf16 v[80:95], v[56:59], a[172:175], v[80:95]
    ds_read_b128 a[180:183], v30 offset:36864
    ds_read_b64_tr_b16 v[52:53], v36 offset:45056
    ds_read_b64_tr_b16 v[54:55], v36 offset:45568
    v_mfma_f32_32x32x16_bf16 v[96:111], a[168:171], v[60:63], v[96:111]
    buffer_load_dwordx4 v22, s[12:15], s41 offen offset:2048 lds
    v_mfma_f32_32x32x16_bf16 v[112:127], a[172:175], v[60:63], v[112:127]
    buffer_load_dwordx4 v23, s[12:15], s41 offen offset:3072 lds
    s_waitcnt lgkmcnt(0)
    s_nop 0
    v_mfma_f32_32x32x16_bf16 v[64:79], v[48:51], a[176:179], v[64:79]
    ds_read_b128 a[184:187], v31 offset:32768
    ds_read_b64_tr_b16 v[56:57], v36 offset:38912
    ds_read_b64_tr_b16 v[58:59], v36 offset:39424
    v_mfma_f32_32x32x16_bf16 v[80:95], v[48:51], a[180:183], v[80:95]
    ds_read_b128 a[188:191], v31 offset:36864
    ds_read_b64_tr_b16 v[60:61], v36 offset:47104
    ds_read_b64_tr_b16 v[62:63], v36 offset:47616
    v_mfma_f32_32x32x16_bf16 v[96:111], a[176:179], v[52:55], v[96:111]
    buffer_store_dword v248, v249, s[20:23], s65 offen sc1
    v_mfma_f32_32x32x16_bf16 v[112:127], a[180:183], v[52:55], v[112:127]
    buffer_store_dwordx4 v[236:239], v253, s[20:23], s80 offen sc1
    s_waitcnt vmcnt(14) lgkmcnt(0)
    v_mfma_f32_32x32x16_bf16 v[64:79], v[56:59], a[184:187], v[64:79]
    s_barrier
    ds_read_b128 a[192:195], v32 offset:0
    ds_read_b64_tr_b16 v[48:49], v37 offset:0
    ds_read_b64_tr_b16 v[50:51], v37 offset:512
    v_mfma_f32_32x32x16_bf16 v[80:95], v[56:59], a[188:191], v[80:95]
    ds_read_b128 a[196:199], v32 offset:4096
    ds_read_b64_tr_b16 v[52:53], v37 offset:8192
    ds_read_b64_tr_b16 v[54:55], v37 offset:8704
    v_mfma_f32_32x32x16_bf16 v[96:111], a[184:187], v[60:63], v[96:111]
    buffer_store_dwordx4 v[236:239], v41, s[20:23], s80 offen sc1
    v_mfma_f32_32x32x16_bf16 v[112:127], a[188:191], v[60:63], v[112:127]
    s_waitcnt lgkmcnt(0)
    v_mfma_f32_32x32x16_bf16 v[64:79], v[48:51], a[192:195], v[64:79]
    ds_read_b128 a[200:203], v33 offset:0
    ds_read_b64_tr_b16 v[56:57], v37 offset:2048
    ds_read_b64_tr_b16 v[58:59], v37 offset:2560
    v_mfma_f32_32x32x16_bf16 v[80:95], v[48:51], a[196:199], v[80:95]
    ds_read_b128 a[204:207], v33 offset:4096
    ds_read_b64_tr_b16 v[60:61], v37 offset:10240
    ds_read_b64_tr_b16 v[62:63], v37 offset:10752
    v_mfma_f32_32x32x16_bf16 v[96:111], a[192:195], v[52:55], v[96:111]
    s_add_u32 m0, s48, 0x24000
    s_add_u32 s41, s47, 2
    s_add_u32 s41, s41, s28
    s_and_b32 s41, s41, 7
    s_mul_i32 s41, s41, 196608
    buffer_load_dwordx4 v20, s[12:15], s41 offen offset:0 lds
    v_mfma_f32_32x32x16_bf16 v[112:127], a[196:199], v[52:55], v[112:127]
    buffer_load_dwordx4 v21, s[12:15], s41 offen offset:1024 lds
    s_waitcnt lgkmcnt(0)
    s_nop 0
    v_mfma_f32_32x32x16_bf16 v[64:79], v[56:59], a[200:203], v[64:79]
    ds_read_b128 a[208:211], v34 offset:0
    ds_read_b64_tr_b16 v[48:49], v37 offset:4096
    ds_read_b64_tr_b16 v[50:51], v37 offset:4608
    v_mfma_f32_32x32x16_bf16 v[80:95], v[56:59], a[204:207], v[80:95]
    ds_read_b128 a[212:215], v34 offset:4096
    ds_read_b64_tr_b16 v[52:53], v37 offset:12288
    ds_read_b64_tr_b16 v[54:55], v37 offset:12800
    v_mfma_f32_32x32x16_bf16 v[96:111], a[200:203], v[60:63], v[96:111]
    buffer_load_dwordx4 v22, s[12:15], s41 offen offset:2048 lds
    v_mfma_f32_32x32x16_bf16 v[112:127], a[204:207], v[60:63], v[112:127]
    buffer_load_dwordx4 v23, s[12:15], s41 offen offset:3072 lds
    s_waitcnt lgkmcnt(0)
    v_mfma_f32_32x32x16_bf16 v[64:79], v[48:51], a[208:211], v[64:79]
    ds_read_b128 a[216:219], v35 offset:0
    ds_read_b64_tr_b16 v[56:57], v37 offset:6144
    ds_read_b64_tr_b16 v[58:59], v37 offset:6656
    v_mfma_f32_32x32x16_bf16 v[80:95], v[48:51], a[212:215], v[80:95]
    ds_read_b128 a[220:223], v35 offset:4096
    ds_read_b64_tr_b16 v[60:61], v37 offset:14336
    ds_read_b64_tr_b16 v[62:63], v37 offset:14848
    v_mfma_f32_32x32x16_bf16 v[96:111], a[208:211], v[52:55], v[96:111]
    v_mfma_f32_32x32x16_bf16 v[112:127], a[212:215], v[52:55], v[112:127]
    s_waitcnt vmcnt(11) lgkmcnt(0)
    v_mfma_f32_32x32x16_bf16 v[64:79], v[56:59], a[216:219], v[64:79]
    s_barrier
    ds_read_b128 a[224:227], v32 offset:32768
    ds_read_b64_tr_b16 v[48:49], v37 offset:32768
    ds_read_b64_tr_b16 v[50:51], v37 offset:33280
    v_mfma_f32_32x32x16_bf16 v[80:95], v[56:59], a[220:223], v[80:95]
    ds_read_b128 a[228:231], v32 offset:36864
    ds_read_b64_tr_b16 v[52:53], v37 offset:40960
    ds_read_b64_tr_b16 v[54:55], v37 offset:41472
    v_mfma_f32_32x32x16_bf16 v[96:111], a[216:219], v[60:63], v[96:111]
    v_mfma_f32_32x32x16_bf16 v[112:127], a[220:223], v[60:63], v[112:127]
    s_waitcnt lgkmcnt(0)
    v_mfma_f32_32x32x16_bf16 v[64:79], v[48:51], a[224:227], v[64:79]
    ds_read_b128 a[232:235], v33 offset:32768
    ds_read_b64_tr_b16 v[56:57], v37 offset:34816
    ds_read_b64_tr_b16 v[58:59], v37 offset:35328
    v_mfma_f32_32x32x16_bf16 v[80:95], v[48:51], a[228:231], v[80:95]
    ds_read_b128 a[236:239], v33 offset:36864
    ds_read_b64_tr_b16 v[60:61], v37 offset:43008
    ds_read_b64_tr_b16 v[62:63], v37 offset:43520
    v_mfma_f32_32x32x16_bf16 v[96:111], a[224:227], v[52:55], v[96:111]
    s_add_u32 m0, s48, 0x8000
    s_cmp_eq_u32 s28, 0
    s_cselect_b32 s41, s63, s44
    s_lshl_b32 s41, s41, 16
    buffer_load_dwordx4 v24, s[16:19], s41 offen offset:0 lds
    v_mfma_f32_32x32x16_bf16 v[112:127], a[228:231], v[52:55], v[112:127]
    buffer_load_dwordx4 v25, s[16:19], s41 offen offset:1024 lds
    s_waitcnt lgkmcnt(0)
    v_mfma_f32_32x32x16_bf16 v[64:79], v[56:59], a[232:235], v[64:79]
    ds_read_b128 a[240:243], v34 offset:32768
    ds_read_b64_tr_b16 v[48:49], v37 offset:36864
    ds_read_b64_tr_b16 v[50:51], v37 offset:37376
    v_mfma_f32_32x32x16_bf16 v[80:95], v[56:59], a[236:239], v[80:95]
    ds_read_b128 a[244:247], v34 offset:36864
    ds_read_b64_tr_b16 v[52:53], v37 offset:45056
    ds_read_b64_tr_b16 v[54:55], v37 offset:45568
    v_mfma_f32_32x32x16_bf16 v[96:111], a[232:235], v[60:63], v[96:111]
    buffer_load_dwordx4 v26, s[16:19], s41 offen offset:2048 lds
    v_mfma_f32_32x32x16_bf16 v[112:127], a[236:239], v[60:63], v[112:127]
    buffer_load_dwordx4 v27, s[16:19], s41 offen offset:3072 lds
    s_waitcnt lgkmcnt(0)
    v_mfma_f32_32x32x16_bf16 v[64:79], v[48:51], a[240:243], v[64:79]
    ds_read_b128 a[248:251], v35 offset:32768
    ds_read_b64_tr_b16 v[56:57], v37 offset:38912
    ds_read_b64_tr_b16 v[58:59], v37 offset:39424
    v_mfma_f32_32x32x16_bf16 v[80:95], v[48:51], a[244:247], v[80:95]
    ds_read_b128 a[252:255], v35 offset:36864
    ds_read_b64_tr_b16 v[60:61], v37 offset:47104
    ds_read_b64_tr_b16 v[62:63], v37 offset:47616
    v_mfma_f32_32x32x16_bf16 v[96:111], a[240:243], v[52:55], v[96:111]
    v_xor_b32 v224, v4, v224
    v_xor_b32 v225, v4, v225
    v_xor_b32 v226, v4, v226
    v_xor_b32 v227, v4, v227
    v_mfma_f32_32x32x16_bf16 v[112:127], a[244:247], v[52:55], v[112:127]
    v_xor_b32 v228, v4, v228
    v_xor_b32 v229, v4, v229
    v_xor_b32 v230, v4, v230
    v_xor_b32 v231, v4, v231
    s_waitcnt lgkmcnt(0)
    v_mfma_f32_32x32x16_bf16 v[64:79], v[56:59], a[248:251], v[64:79]
    s_barrier
    v_mfma_f32_32x32x16_bf16 v[80:95], v[56:59], a[252:255], v[80:95]
    v_mfma_f32_32x32x16_bf16 v[96:111], a[248:251], v[60:63], v[96:111]
    v_mfma_f32_32x32x16_bf16 v[112:127], a[252:255], v[60:63], v[112:127]
    s_nop 7
    v_cvt_pk_bf16_f32 v64, v64, v65
    v_cvt_pk_bf16_f32 v65, v66, v67
    v_cvt_pk_bf16_f32 v66, v68, v69
    v_cvt_pk_bf16_f32 v67, v70, v71
    v_cvt_pk_bf16_f32 v68, v72, v73
    v_cvt_pk_bf16_f32 v69, v74, v75
    v_cvt_pk_bf16_f32 v70, v76, v77
    v_cvt_pk_bf16_f32 v71, v78, v79
    v_mfma_f32_32x32x16_bf16 v[128:143], v[224:227], v[64:67], 0
    s_nop 0
    v_mfma_f32_32x32x16_bf16 v[144:159], v[228:231], v[68:71], 0
    v_cvt_pk_bf16_f32 v80, v80, v81
    v_cvt_pk_bf16_f32 v81, v82, v83
    v_cvt_pk_bf16_f32 v82, v84, v85
    v_cvt_pk_bf16_f32 v83, v86, v87
    v_cvt_pk_bf16_f32 v84, v88, v89
    v_cvt_pk_bf16_f32 v85, v90, v91
    v_cvt_pk_bf16_f32 v86, v92, v93
    v_cvt_pk_bf16_f32 v87, v94, v95
    v_mfma_f32_32x32x16_bf16 v[160:175], v[224:227], v[80:83], 0
    s_nop 0
    v_mfma_f32_32x32x16_bf16 v[176:191], v[228:231], v[84:87], 0
    v_cvt_pk_bf16_f32 v96, v96, v97
    v_cvt_pk_bf16_f32 v97, v98, v99
    v_cvt_pk_bf16_f32 v98, v100, v101
    v_cvt_pk_bf16_f32 v99, v102, v103
    v_cvt_pk_bf16_f32 v100, v104, v105
    v_cvt_pk_bf16_f32 v101, v106, v107
    v_cvt_pk_bf16_f32 v102, v108, v109
    v_cvt_pk_bf16_f32 v103, v110, v111
    v_cvt_pk_bf16_f32 v112, v112, v113
    v_cvt_pk_bf16_f32 v113, v114, v115
    v_cvt_pk_bf16_f32 v114, v116, v117
    v_cvt_pk_bf16_f32 v115, v118, v119
    v_cvt_pk_bf16_f32 v116, v120, v121
    v_cvt_pk_bf16_f32 v117, v122, v123
    v_cvt_pk_bf16_f32 v118, v124, v125
    v_cvt_pk_bf16_f32 v119, v126, v127
    v_cndmask_b32_e64 v104, v3, v96, s[60:61]
    v_cndmask_b32_e64 v96, v96, v3, s[60:61]
    v_cndmask_b32_e64 v105, v3, v97, s[60:61]
    v_cndmask_b32_e64 v97, v97, v3, s[60:61]
    v_cndmask_b32_e64 v106, v3, v98, s[60:61]
    v_cndmask_b32_e64 v98, v98, v3, s[60:61]
    v_cndmask_b32_e64 v107, v3, v99, s[60:61]
    v_cndmask_b32_e64 v99, v99, v3, s[60:61]
    v_cndmask_b32_e64 v108, v3, v100, s[60:61]
    v_cndmask_b32_e64 v100, v100, v3, s[60:61]
    v_cndmask_b32_e64 v109, v3, v101, s[60:61]
    v_cndmask_b32_e64 v101, v101, v3, s[60:61]
    v_cndmask_b32_e64 v110, v3, v102, s[60:61]
    v_cndmask_b32_e64 v102, v102, v3, s[60:61]
    v_cndmask_b32_e64 v111, v3, v103, s[60:61]
    v_cndmask_b32_e64 v103, v103, v3, s[60:61]
    v_cndmask_b32_e64 v120, v3, v112, s[60:61]
    v_cndmask_b32_e64 v112, v112, v3, s[60:61]
    v_cndmask_b32_e64 v121, v3, v113, s[60:61]
    v_cndmask_b32_e64 v113, v113, v3, s[60:61]
    v_cndmask_b32_e64 v122, v3, v114, s[60:61]
    v_cndmask_b32_e64 v114, v114, v3, s[60:61]
    v_cndmask_b32_e64 v123, v3, v115, s[60:61]
    v_cndmask_b32_e64 v115, v115, v3, s[60:61]
    v_cndmask_b32_e64 v124, v3, v116, s[60:61]
    v_cndmask_b32_e64 v116, v116, v3, s[60:61]
    v_cndmask_b32_e64 v125, v3, v117, s[60:61]
    v_cndmask_b32_e64 v117, v117, v3, s[60:61]
    v_cndmask_b32_e64 v126, v3, v118, s[60:61]
    v_cndmask_b32_e64 v118, v118, v3, s[60:61]
    v_cndmask_b32_e64 v127, v3, v119, s[60:61]
    v_cndmask_b32_e64 v119, v119, v3, s[60:61]
    v_max3_f32 v232, v128, v129, v130
    v_max3_f32 v232, v232, v131, v132
    v_max3_f32 v232, v232, v133, v134
    v_max3_f32 v232, v232, v135, v136
    v_max3_f32 v232, v232, v137, v138
    v_max3_f32 v232, v232, v139, v140
    v_max3_f32 v232, v232, v141, v142
    v_max_f32 v232, v232, v143
    v_mul_f32 v232, s54, v232
    v_pk_fma_f32 v[128:129], v[128:129], s[54:55], v[232:233] op_sel_hi:[1,1,0] neg_lo:[0,0,1] neg_hi:[0,0,1]
    v_pk_fma_f32 v[130:131], v[130:131], s[54:55], v[232:233] op_sel_hi:[1,1,0] neg_lo:[0,0,1] neg_hi:[0,0,1]
    v_pk_fma_f32 v[132:133], v[132:133], s[54:55], v[232:233] op_sel_hi:[1,1,0] neg_lo:[0,0,1] neg_hi:[0,0,1]
    v_pk_fma_f32 v[134:135], v[134:135], s[54:55], v[232:233] op_sel_hi:[1,1,0] neg_lo:[0,0,1] neg_hi:[0,0,1]
    v_pk_fma_f32 v[136:137], v[136:137], s[54:55], v[232:233] op_sel_hi:[1,1,0] neg_lo:[0,0,1] neg_hi:[0,0,1]
    v_pk_fma_f32 v[138:139], v[138:139], s[54:55], v[232:233] op_sel_hi:[1,1,0] neg_lo:[0,0,1] neg_hi:[0,0,1]
    v_pk_fma_f32 v[140:141], v[140:141], s[54:55], v[232:233] op_sel_hi:[1,1,0] neg_lo:[0,0,1] neg_hi:[0,0,1]
    v_pk_fma_f32 v[142:143], v[142:143], s[54:55], v[232:233] op_sel_hi:[1,1,0] neg_lo:[0,0,1] neg_hi:[0,0,1]
    v_exp_f32 v128, v128
    v_exp_f32 v129, v129
    v_exp_f32 v130, v130
    v_exp_f32 v131, v131
    v_exp_f32 v132, v132
    v_exp_f32 v133, v133
    v_exp_f32 v134, v134
    v_exp_f32 v135, v135
    v_exp_f32 v136, v136
    v_exp_f32 v137, v137
    v_exp_f32 v138, v138
    v_exp_f32 v139, v139
    v_exp_f32 v140, v140
    v_exp_f32 v141, v141
    v_exp_f32 v142, v142
    v_exp_f32 v143, v143
    v_pk_add_f32 v[234:235], v[128:129], v[130:131]
    v_pk_add_f32 v[234:235], v[234:235], v[132:133]
    v_pk_add_f32 v[234:235], v[234:235], v[134:135]
    v_pk_add_f32 v[234:235], v[234:235], v[136:137]
    v_pk_add_f32 v[234:235], v[234:235], v[138:139]
    v_pk_add_f32 v[234:235], v[234:235], v[140:141]
    v_pk_add_f32 v[234:235], v[234:235], v[142:143]
    v_add_f32_e64 v234, v234, v235
    v_rcp_f32 v234, v234
    s_nop 0
    v_pk_mul_f32 v[128:129], v[128:129], v[234:235] op_sel_hi:[1,0]
    v_pk_mul_f32 v[130:131], v[130:131], v[234:235] op_sel_hi:[1,0]
    v_pk_mul_f32 v[132:133], v[132:133], v[234:235] op_sel_hi:[1,0]
    v_pk_mul_f32 v[134:135], v[134:135], v[234:235] op_sel_hi:[1,0]
    v_pk_mul_f32 v[136:137], v[136:137], v[234:235] op_sel_hi:[1,0]
    v_pk_mul_f32 v[138:139], v[138:139], v[234:235] op_sel_hi:[1,0]
    v_pk_mul_f32 v[140:141], v[140:141], v[234:235] op_sel_hi:[1,0]
    v_pk_mul_f32 v[142:143], v[142:143], v[234:235] op_sel_hi:[1,0]
    v_cvt_pk_bf16_f32 v72, v128, v129
    v_cvt_pk_bf16_f32 v73, v130, v131
    v_cvt_pk_bf16_f32 v74, v132, v133
    v_cvt_pk_bf16_f32 v75, v134, v135
    v_cvt_pk_bf16_f32 v76, v136, v137
    v_cvt_pk_bf16_f32 v77, v138, v139
    v_cvt_pk_bf16_f32 v78, v140, v141
    v_cvt_pk_bf16_f32 v79, v142, v143
    v_max3_f32 v232, v144, v145, v146
    v_max3_f32 v232, v232, v147, v148
    v_max3_f32 v232, v232, v149, v150
    v_max3_f32 v232, v232, v151, v152
    v_max3_f32 v232, v232, v153, v154
    v_max3_f32 v232, v232, v155, v156
    v_max3_f32 v232, v232, v157, v158
    v_max_f32 v232, v232, v159
    v_mul_f32 v232, s54, v232
    v_pk_fma_f32 v[144:145], v[144:145], s[54:55], v[232:233] op_sel_hi:[1,1,0] neg_lo:[0,0,1] neg_hi:[0,0,1]
    v_pk_fma_f32 v[146:147], v[146:147], s[54:55], v[232:233] op_sel_hi:[1,1,0] neg_lo:[0,0,1] neg_hi:[0,0,1]
    v_pk_fma_f32 v[148:149], v[148:149], s[54:55], v[232:233] op_sel_hi:[1,1,0] neg_lo:[0,0,1] neg_hi:[0,0,1]
    v_pk_fma_f32 v[150:151], v[150:151], s[54:55], v[232:233] op_sel_hi:[1,1,0] neg_lo:[0,0,1] neg_hi:[0,0,1]
    v_pk_fma_f32 v[152:153], v[152:153], s[54:55], v[232:233] op_sel_hi:[1,1,0] neg_lo:[0,0,1] neg_hi:[0,0,1]
    v_pk_fma_f32 v[154:155], v[154:155], s[54:55], v[232:233] op_sel_hi:[1,1,0] neg_lo:[0,0,1] neg_hi:[0,0,1]
    v_pk_fma_f32 v[156:157], v[156:157], s[54:55], v[232:233] op_sel_hi:[1,1,0] neg_lo:[0,0,1] neg_hi:[0,0,1]
    v_pk_fma_f32 v[158:159], v[158:159], s[54:55], v[232:233] op_sel_hi:[1,1,0] neg_lo:[0,0,1] neg_hi:[0,0,1]
    v_mfma_f32_32x32x16_bf16 v[128:143], v[72:75], v[240:243], 0
    s_add_u32 m0, s48, 0x0
    s_add_u32 s41, s47, 4
    s_add_u32 s41, s41, s28
    s_and_b32 s41, s41, 7
    s_mul_i32 s41, s41, 196608
    buffer_load_dwordx4 v20, s[12:15], s41 offen offset:0 lds
    v_exp_f32 v144, v144
    v_exp_f32 v145, v145
    v_exp_f32 v146, v146
    v_exp_f32 v147, v147
    v_mfma_f32_32x32x16_bf16 v[128:143], v[76:79], v[244:247], v[128:143]
    buffer_load_dwordx4 v21, s[12:15], s41 offen offset:1024 lds
    v_exp_f32 v148, v148
    v_exp_f32 v149, v149
    v_exp_f32 v150, v150
    v_exp_f32 v151, v151
    v_exp_f32 v152, v152
    v_exp_f32 v153, v153
    v_exp_f32 v154, v154
    v_exp_f32 v155, v155
    v_exp_f32 v156, v156
    v_exp_f32 v157, v157
    v_exp_f32 v158, v158
    v_exp_f32 v159, v159
    v_cvt_pk_bf16_f32 v128, v128, v129
    v_cvt_pk_bf16_f32 v129, v130, v131
    v_cvt_pk_bf16_f32 v130, v132, v133
    v_cvt_pk_bf16_f32 v131, v134, v135
    v_cvt_pk_bf16_f32 v132, v136, v137
    v_cvt_pk_bf16_f32 v133, v138, v139
    v_cvt_pk_bf16_f32 v134, v140, v141
    v_cvt_pk_bf16_f32 v135, v142, v143
    v_pk_add_f32 v[234:235], v[144:145], v[146:147]
    v_pk_add_f32 v[234:235], v[234:235], v[148:149]
    v_pk_add_f32 v[234:235], v[234:235], v[150:151]
    v_pk_add_f32 v[234:235], v[234:235], v[152:153]
    v_pk_add_f32 v[234:235], v[234:235], v[154:155]
    v_pk_add_f32 v[234:235], v[234:235], v[156:157]
    v_pk_add_f32 v[234:235], v[234:235], v[158:159]
    v_add_f32_e64 v234, v234, v235
    v_rcp_f32 v234, v234
    s_nop 0
    v_pk_mul_f32 v[144:145], v[144:145], v[234:235] op_sel_hi:[1,0]
    v_pk_mul_f32 v[146:147], v[146:147], v[234:235] op_sel_hi:[1,0]
    v_pk_mul_f32 v[148:149], v[148:149], v[234:235] op_sel_hi:[1,0]
    v_pk_mul_f32 v[150:151], v[150:151], v[234:235] op_sel_hi:[1,0]
    v_pk_mul_f32 v[152:153], v[152:153], v[234:235] op_sel_hi:[1,0]
    v_pk_mul_f32 v[154:155], v[154:155], v[234:235] op_sel_hi:[1,0]
    v_pk_mul_f32 v[156:157], v[156:157], v[234:235] op_sel_hi:[1,0]
    v_pk_mul_f32 v[158:159], v[158:159], v[234:235] op_sel_hi:[1,0]
    v_mfma_f32_32x32x16_bf16 v[192:207], v[128:131], v[96:99], 0
    buffer_load_dwordx4 v22, s[12:15], s41 offen offset:2048 lds
    v_cvt_pk_bf16_f32 v88, v144, v145
    v_cvt_pk_bf16_f32 v89, v146, v147
    v_cvt_pk_bf16_f32 v90, v148, v149
    v_cvt_pk_bf16_f32 v91, v150, v151
    v_cvt_pk_bf16_f32 v92, v152, v153
    v_cvt_pk_bf16_f32 v93, v154, v155
    v_cvt_pk_bf16_f32 v94, v156, v157
    v_cvt_pk_bf16_f32 v95, v158, v159
    v_mfma_f32_32x32x16_bf16 v[192:207], v[132:135], v[100:103], v[192:207]
    buffer_load_dwordx4 v23, s[12:15], s41 offen offset:3072 lds
    v_max3_f32 v232, v160, v161, v162
    v_max3_f32 v232, v232, v163, v164
    v_max3_f32 v232, v232, v165, v166
    v_max3_f32 v232, v232, v167, v168
    v_max3_f32 v232, v232, v169, v170
    v_max3_f32 v232, v232, v171, v172
    v_max3_f32 v232, v232, v173, v174
    v_max_f32 v232, v232, v175
    v_mul_f32 v232, s54, v232
    v_pk_fma_f32 v[160:161], v[160:161], s[54:55], v[232:233] op_sel_hi:[1,1,0] neg_lo:[0,0,1] neg_hi:[0,0,1]
    v_pk_fma_f32 v[162:163], v[162:163], s[54:55], v[232:233] op_sel_hi:[1,1,0] neg_lo:[0,0,1] neg_hi:[0,0,1]
    v_pk_fma_f32 v[164:165], v[164:165], s[54:55], v[232:233] op_sel_hi:[1,1,0] neg_lo:[0,0,1] neg_hi:[0,0,1]
    v_pk_fma_f32 v[166:167], v[166:167], s[54:55], v[232:233] op_sel_hi:[1,1,0] neg_lo:[0,0,1] neg_hi:[0,0,1]
    v_pk_fma_f32 v[168:169], v[168:169], s[54:55], v[232:233] op_sel_hi:[1,1,0] neg_lo:[0,0,1] neg_hi:[0,0,1]
    v_pk_fma_f32 v[170:171], v[170:171], s[54:55], v[232:233] op_sel_hi:[1,1,0] neg_lo:[0,0,1] neg_hi:[0,0,1]
    v_pk_fma_f32 v[172:173], v[172:173], s[54:55], v[232:233] op_sel_hi:[1,1,0] neg_lo:[0,0,1] neg_hi:[0,0,1]
    v_pk_fma_f32 v[174:175], v[174:175], s[54:55], v[232:233] op_sel_hi:[1,1,0] neg_lo:[0,0,1] neg_hi:[0,0,1]
    v_mfma_f32_32x32x16_bf16 v[144:159], v[88:91], v[240:243], 0
    s_add_u32 m0, s48, 0x4000
    s_add_u32 s41, s47, 6
    s_add_u32 s41, s41, s28
    s_and_b32 s41, s41, 7
    s_mul_i32 s41, s41, 196608
    buffer_load_dwordx4 v20, s[12:15], s41 offen offset:0 lds
    v_exp_f32_e64 v160, v160
    v_exp_f32 v161, v161
    v_exp_f32 v162, v162
    v_exp_f32 v163, v163
    v_mfma_f32_32x32x16_bf16 v[144:159], v[92:95], v[244:247], v[144:159]
    buffer_load_dwordx4 v21, s[12:15], s41 offen offset:1024 lds
    v_exp_f32 v164, v164
    v_exp_f32 v165, v165
    v_exp_f32 v166, v166
    v_exp_f32 v167, v167
    v_exp_f32 v168, v168
    v_exp_f32 v169, v169
    v_exp_f32 v170, v170
    v_exp_f32 v171, v171
    v_exp_f32 v172, v172
    v_exp_f32 v173, v173
    v_exp_f32 v174, v174
    v_exp_f32 v175, v175
    v_cvt_pk_bf16_f32 v144, v144, v145
    v_cvt_pk_bf16_f32 v145, v146, v147
    v_cvt_pk_bf16_f32 v146, v148, v149
    v_cvt_pk_bf16_f32 v147, v150, v151
    v_cvt_pk_bf16_f32 v148, v152, v153
    v_cvt_pk_bf16_f32 v149, v154, v155
    v_cvt_pk_bf16_f32 v150, v156, v157
    v_cvt_pk_bf16_f32 v151, v158, v159
    v_pk_add_f32 v[234:235], v[160:161], v[162:163]
    v_pk_add_f32 v[234:235], v[234:235], v[164:165]
    v_pk_add_f32 v[234:235], v[234:235], v[166:167]
    v_pk_add_f32 v[234:235], v[234:235], v[168:169]
    v_pk_add_f32 v[234:235], v[234:235], v[170:171]
    v_pk_add_f32 v[234:235], v[234:235], v[172:173]
    v_pk_add_f32 v[234:235], v[234:235], v[174:175]
    v_add_f32_e64 v234, v234, v235
    v_rcp_f32 v234, v234
    s_nop 0
    v_pk_mul_f32 v[160:161], v[160:161], v[234:235] op_sel_hi:[1,0]
    v_pk_mul_f32 v[162:163], v[162:163], v[234:235] op_sel_hi:[1,0]
    v_pk_mul_f32 v[164:165], v[164:165], v[234:235] op_sel_hi:[1,0]
    v_pk_mul_f32 v[166:167], v[166:167], v[234:235] op_sel_hi:[1,0]
    v_pk_mul_f32 v[168:169], v[168:169], v[234:235] op_sel_hi:[1,0]
    v_pk_mul_f32 v[170:171], v[170:171], v[234:235] op_sel_hi:[1,0]
    v_pk_mul_f32 v[172:173], v[172:173], v[234:235] op_sel_hi:[1,0]
    v_pk_mul_f32 v[174:175], v[174:175], v[234:235] op_sel_hi:[1,0]
    v_mfma_f32_32x32x16_bf16 v[208:223], v[144:147], v[104:107], 0
    buffer_load_dwordx4 v22, s[12:15], s41 offen offset:2048 lds
    v_cvt_pk_bf16_f32 v72, v160, v161
    v_cvt_pk_bf16_f32 v73, v162, v163
    v_cvt_pk_bf16_f32 v74, v164, v165
    v_cvt_pk_bf16_f32 v75, v166, v167
    v_cvt_pk_bf16_f32 v76, v168, v169
    v_cvt_pk_bf16_f32 v77, v170, v171
    v_cvt_pk_bf16_f32 v78, v172, v173
    v_cvt_pk_bf16_f32 v79, v174, v175
    v_mfma_f32_32x32x16_bf16 v[208:223], v[148:151], v[108:111], v[208:223]
    buffer_load_dwordx4 v23, s[12:15], s41 offen offset:3072 lds
    v_max3_f32 v232, v176, v177, v178
    v_max3_f32 v232, v232, v179, v180
    v_max3_f32 v232, v232, v181, v182
    v_max3_f32 v232, v232, v183, v184
    v_max3_f32 v232, v232, v185, v186
    v_max3_f32 v232, v232, v187, v188
    v_max3_f32 v232, v232, v189, v190
    v_max_f32 v232, v232, v191
    v_mul_f32 v232, s54, v232
    v_pk_fma_f32 v[176:177], v[176:177], s[54:55], v[232:233] op_sel_hi:[1,1,0] neg_lo:[0,0,1] neg_hi:[0,0,1]
    v_pk_fma_f32 v[178:179], v[178:179], s[54:55], v[232:233] op_sel_hi:[1,1,0] neg_lo:[0,0,1] neg_hi:[0,0,1]
    v_pk_fma_f32 v[180:181], v[180:181], s[54:55], v[232:233] op_sel_hi:[1,1,0] neg_lo:[0,0,1] neg_hi:[0,0,1]
    v_pk_fma_f32 v[182:183], v[182:183], s[54:55], v[232:233] op_sel_hi:[1,1,0] neg_lo:[0,0,1] neg_hi:[0,0,1]
    v_pk_fma_f32 v[184:185], v[184:185], s[54:55], v[232:233] op_sel_hi:[1,1,0] neg_lo:[0,0,1] neg_hi:[0,0,1]
    v_pk_fma_f32 v[186:187], v[186:187], s[54:55], v[232:233] op_sel_hi:[1,1,0] neg_lo:[0,0,1] neg_hi:[0,0,1]
    v_pk_fma_f32 v[188:189], v[188:189], s[54:55], v[232:233] op_sel_hi:[1,1,0] neg_lo:[0,0,1] neg_hi:[0,0,1]
    v_pk_fma_f32 v[190:191], v[190:191], s[54:55], v[232:233] op_sel_hi:[1,1,0] neg_lo:[0,0,1] neg_hi:[0,0,1]
    v_mfma_f32_32x32x16_bf16 v[160:175], v[72:75], v[240:243], 0
    s_add_u32 m0, s48, 0xc000
    s_cmp_eq_u32 s28, 0
    s_cselect_b32 s41, s62, s45
    s_lshl_b32 s41, s41, 16
    buffer_load_dwordx4 v24, s[16:19], s41 offen offset:0 lds
    v_exp_f32_e64 v176, v176
    v_exp_f32 v177, v177
    v_exp_f32 v178, v178
    v_exp_f32 v179, v179
    v_mfma_f32_32x32x16_bf16 v[160:175], v[76:79], v[244:247], v[160:175]
    buffer_load_dwordx4 v25, s[16:19], s41 offen offset:1024 lds
    v_exp_f32 v180, v180
    v_exp_f32 v181, v181
    v_exp_f32 v182, v182
    v_exp_f32 v183, v183
    v_exp_f32 v184, v184
    v_exp_f32 v185, v185
    v_exp_f32 v186, v186
    v_exp_f32 v187, v187
    v_exp_f32 v188, v188
    v_exp_f32 v189, v189
    v_exp_f32 v190, v190
    v_exp_f32 v191, v191
    v_cvt_pk_bf16_f32 v160, v160, v161
    v_cvt_pk_bf16_f32 v161, v162, v163
    v_cvt_pk_bf16_f32 v162, v164, v165
    v_cvt_pk_bf16_f32 v163, v166, v167
    v_cvt_pk_bf16_f32 v164, v168, v169
    v_cvt_pk_bf16_f32 v165, v170, v171
    v_cvt_pk_bf16_f32 v166, v172, v173
    v_cvt_pk_bf16_f32 v167, v174, v175
    v_pk_add_f32 v[234:235], v[176:177], v[178:179]
    v_pk_add_f32 v[234:235], v[234:235], v[180:181]
    v_pk_add_f32 v[234:235], v[234:235], v[182:183]
    v_pk_add_f32 v[234:235], v[234:235], v[184:185]
    v_pk_add_f32 v[234:235], v[234:235], v[186:187]
    v_pk_add_f32 v[234:235], v[234:235], v[188:189]
    v_pk_add_f32 v[234:235], v[234:235], v[190:191]
    v_add_f32_e64 v234, v234, v235
    v_rcp_f32 v234, v234
    s_nop 0
    v_pk_mul_f32 v[176:177], v[176:177], v[234:235] op_sel_hi:[1,0]
    v_pk_mul_f32 v[178:179], v[178:179], v[234:235] op_sel_hi:[1,0]
    v_pk_mul_f32 v[180:181], v[180:181], v[234:235] op_sel_hi:[1,0]
    v_pk_mul_f32 v[182:183], v[182:183], v[234:235] op_sel_hi:[1,0]
    v_pk_mul_f32 v[184:185], v[184:185], v[234:235] op_sel_hi:[1,0]
    v_pk_mul_f32 v[186:187], v[186:187], v[234:235] op_sel_hi:[1,0]
    v_pk_mul_f32 v[188:189], v[188:189], v[234:235] op_sel_hi:[1,0]
    v_pk_mul_f32 v[190:191], v[190:191], v[234:235] op_sel_hi:[1,0]
    v_mfma_f32_32x32x16_bf16 v[192:207], v[160:163], v[112:115], v[192:207]
    buffer_load_dwordx4 v26, s[16:19], s41 offen offset:2048 lds
    v_cvt_pk_bf16_f32 v88, v176, v177
    v_cvt_pk_bf16_f32 v89, v178, v179
    v_cvt_pk_bf16_f32 v90, v180, v181
    v_cvt_pk_bf16_f32 v91, v182, v183
    v_cvt_pk_bf16_f32 v92, v184, v185
    v_cvt_pk_bf16_f32 v93, v186, v187
    v_cvt_pk_bf16_f32 v94, v188, v189
    v_cvt_pk_bf16_f32 v95, v190, v191
    v_mfma_f32_32x32x16_bf16 v[192:207], v[164:167], v[116:119], v[192:207]
    buffer_load_dwordx4 v27, s[16:19], s41 offen offset:3072 lds
    s_cmp_lg_u32 s28, 0
    s_cbranch_scc1 L_rh1_23
    v_mfma_f32_32x32x16_bf16 v[176:191], v[88:91], v[240:243], 0
    v_mfma_f32_32x32x16_bf16 v[176:191], v[92:95], v[244:247], v[176:191]
    s_nop 6
    ds_write_b128 v39, v[200:203] offset:0
    ds_write_b128 v39, v[204:207] offset:1024
    s_nop 2
    v_cvt_pk_bf16_f32 v176, v176, v177
    v_cvt_pk_bf16_f32 v177, v178, v179
    v_cvt_pk_bf16_f32 v178, v180, v181
    v_cvt_pk_bf16_f32 v179, v182, v183
    v_cvt_pk_bf16_f32 v180, v184, v185
    v_cvt_pk_bf16_f32 v181, v186, v187
    v_cvt_pk_bf16_f32 v182, v188, v189
    v_cvt_pk_bf16_f32 v183, v190, v191
    v_mfma_f32_32x32x16_bf16 v[208:223], v[176:179], v[120:123], v[208:223]
    s_nop 0
    v_mfma_f32_32x32x16_bf16 v[208:223], v[180:183], v[124:127], v[208:223]
    s_nop 11
    ds_write_b128 v39, v[216:219] offset:2048
    ds_write_b128 v39, v[220:223] offset:3072
    s_waitcnt lgkmcnt(0)
    s_barrier
    ds_read_b128 v[128:131], v40 offset:0
    ds_read_b128 v[132:135], v40 offset:1024
    ds_read_b128 v[136:139], v40 offset:2048
    ds_read_b128 v[140:143], v40 offset:3072
    s_add_u32 s35, s73, 0
    s_waitcnt lgkmcnt(3)
    v_pk_add_f32 v[192:193], v[192:193], v[128:129]
    v_pk_add_f32 v[194:195], v[194:195], v[130:131]
    v_and_or_b32 v192, v192, s82, v8
    buffer_store_dwordx4 v[192:195], v43, s[20:23], s35 offen sc1
    s_add_u32 s35, s73, 10240
    s_waitcnt lgkmcnt(2)
    v_pk_add_f32 v[196:197], v[196:197], v[132:133]
    v_pk_add_f32 v[198:199], v[198:199], v[134:135]
    v_and_or_b32 v196, v196, s82, v8
    buffer_store_dwordx4 v[196:199], v43, s[20:23], s35 offen sc1
    s_add_u32 s35, s73, 40960
    s_waitcnt lgkmcnt(1)
    v_pk_add_f32 v[208:209], v[208:209], v[136:137]
    v_pk_add_f32 v[210:211], v[210:211], v[138:139]
    v_and_or_b32 v208, v208, s82, v8
    buffer_store_dwordx4 v[208:211], v44, s[20:23], s35 offen sc1
    s_add_u32 s35, s73, 51200
    s_waitcnt lgkmcnt(0)
    v_pk_add_f32 v[212:213], v[212:213], v[140:141]
    v_pk_add_f32 v[214:215], v[214:215], v[142:143]
    v_and_or_b32 v212, v212, s82, v8
    buffer_store_dwordx4 v[212:215], v44, s[20:23], s35 offen sc1
    s_branch L_rhj_24
L_rh1_23:
    v_mfma_f32_32x32x16_bf16 v[176:191], v[88:91], v[240:243], 0
    v_mfma_f32_32x32x16_bf16 v[176:191], v[92:95], v[244:247], v[176:191]
    s_nop 6
    ds_write_b128 v39, v[192:195] offset:0
    ds_write_b128 v39, v[196:199] offset:1024
    s_nop 2
    v_cvt_pk_bf16_f32 v176, v176, v177
    v_cvt_pk_bf16_f32 v177, v178, v179
    v_cvt_pk_bf16_f32 v178, v180, v181
    v_cvt_pk_bf16_f32 v179, v182, v183
    v_cvt_pk_bf16_f32 v180, v184, v185
    v_cvt_pk_bf16_f32 v181, v186, v187
    v_cvt_pk_bf16_f32 v182, v188, v189
    v_cvt_pk_bf16_f32 v183, v190, v191
    v_mfma_f32_32x32x16_bf16 v[208:223], v[176:179], v[120:123], v[208:223]
    s_nop 0
    v_mfma_f32_32x32x16_bf16 v[208:223], v[180:183], v[124:127], v[208:223]
    s_nop 11
    ds_write_b128 v39, v[208:211] offset:2048
    ds_write_b128 v39, v[212:215] offset:3072
    s_waitcnt lgkmcnt(0)
    s_barrier
    ds_read_b128 v[128:131], v40 offset:0
    ds_read_b128 v[132:135], v40 offset:1024
    ds_read_b128 v[136:139], v40 offset:2048
    ds_read_b128 v[140:143], v40 offset:3072
    s_add_u32 s35, s73, 0
    s_waitcnt lgkmcnt(3)
    v_pk_add_f32 v[200:201], v[200:201], v[128:129]
    v_pk_add_f32 v[202:203], v[202:203], v[130:131]
    v_and_or_b32 v200, v200, s82, v8
    buffer_store_dwordx4 v[200:203], v43, s[20:23], s35 offen sc1
    s_add_u32 s35, s73, 10240
    s_waitcnt lgkmcnt(2)
    v_pk_add_f32 v[204:205], v[204:205], v[132:133]
    v_pk_add_f32 v[206:207], v[206:207], v[134:135]
    v_and_or_b32 v204, v204, s82, v8
    buffer_store_dwordx4 v[204:207], v43, s[20:23], s35 offen sc1
    s_add_u32 s35, s73, 40960
    s_waitcnt lgkmcnt(1)
    v_pk_add_f32 v[216:217], v[216:217], v[136:137]
    v_pk_add_f32 v[218:219], v[218:219], v[138:139]
    v_and_or_b32 v216, v216, s82, v8
    buffer_store_dwordx4 v[216:219], v44, s[20:23], s35 offen sc1
    s_add_u32 s35, s73, 51200
    s_waitcnt lgkmcnt(0)
    v_pk_add_f32 v[220:221], v[220:221], v[140:141]
    v_pk_add_f32 v[222:223], v[222:223], v[142:143]
    v_and_or_b32 v220, v220, s82, v8
    buffer_store_dwordx4 v[220:223], v44, s[20:23], s35 offen sc1
L_rhj_24:
    s_mov_b32 s83, 0
    s_waitcnt vmcnt(8)
    s_barrier
    ds_read_b64_tr_b16 v[48:49], v38 offset:0
    ds_read_b64_tr_b16 v[50:51], v38 offset:512
    ds_read_b64_tr_b16 v[52:53], v38 offset:2048
    ds_read_b64_tr_b16 v[54:55], v38 offset:2560
    s_waitcnt lgkmcnt(0)
    v_mfma_f32_32x32x16_bf16 v[64:79], v[48:51], a[0:3], 0
    ds_read_b64_tr_b16 v[56:57], v38 offset:4096
    ds_read_b64_tr_b16 v[58:59], v38 offset:4608
    v_mfma_f32_32x32x16_bf16 v[80:95], v[48:51], a[4:7], 0
    ds_read_b64_tr_b16 v[60:61], v38 offset:6144
    ds_read_b64_tr_b16 v[62:63], v38 offset:6656
    v_mfma_f32_32x32x16_bf16 v[64:79], v[52:55], a[8:11], v[64:79]
    s_add_u32 m0, s48, 0x10000
    s_cmp_eq_u32 s28, 0
    s_cselect_b32 s41, s86, s87
    s_lshl_b32 s41, s41, 16
    buffer_load_dwordx4 v24, s[16:19], s41 offen offset:0 lds
    v_mfma_f32_32x32x16_bf16 v[80:95], v[52:55], a[12:15], v[80:95]
    buffer_load_dwordx4 v25, s[16:19], s41 offen offset:1024 lds
    s_waitcnt lgkmcnt(0)
    v_mfma_f32_32x32x16_bf16 v[64:79], v[56:59], a[16:19], v[64:79]
    ds_read_b64_tr_b16 v[48:49], v38 offset:8192
    ds_read_b64_tr_b16 v[50:51], v38 offset:8704
    v_mfma_f32_32x32x16_bf16 v[80:95], v[56:59], a[20:23], v[80:95]
    ds_read_b64_tr_b16 v[52:53], v38 offset:10240
    ds_read_b64_tr_b16 v[54:55], v38 offset:10752
    v_mfma_f32_32x32x16_bf16 v[64:79], v[60:63], a[24:27], v[64:79]
    buffer_load_dwordx4 v26, s[16:19], s41 offen offset:2048 lds
    v_mfma_f32_32x32x16_bf16 v[80:95], v[60:63], a[28:31], v[80:95]
    buffer_load_dwordx4 v27, s[16:19], s41 offen offset:3072 lds
    s_waitcnt lgkmcnt(0)
    v_mfma_f32_32x32x16_bf16 v[64:79], v[48:51], a[32:35], v[64:79]
    ds_read_b64_tr_b16 v[56:57], v38 offset:12288
    ds_read_b64_tr_b16 v[58:59], v38 offset:12800
    v_mfma_f32_32x32x16_bf16 v[80:95], v[48:51], a[36:39], v[80:95]
    ds_read_b64_tr_b16 v[60:61], v38 offset:14336
    ds_read_b64_tr_b16 v[62:63], v38 offset:14848
    v_mfma_f32_32x32x16_bf16 v[64:79], v[52:55], a[40:43], v[64:79]
    s_add_u32 m0, s48, 0x14000
    s_cmp_eq_u32 s28, 0
    s_cselect_b32 s41, s94, s95
    s_lshl_b32 s41, s41, 16
    buffer_load_dwordx4 v24, s[16:19], s41 offen offset:0 lds
    v_mfma_f32_32x32x16_bf16 v[80:95], v[52:55], a[44:47], v[80:95]
    buffer_load_dwordx4 v25, s[16:19], s41 offen offset:1024 lds
    s_waitcnt lgkmcnt(0)
    v_mfma_f32_32x32x16_bf16 v[64:79], v[56:59], a[48:51], v[64:79]
    ds_read_b64_tr_b16 v[48:49], v38 offset:16384
    ds_read_b64_tr_b16 v[50:51], v38 offset:16896
    v_mfma_f32_32x32x16_bf16 v[80:95], v[56:59], a[52:55], v[80:95]
    ds_read_b64_tr_b16 v[52:53], v38 offset:18432
    ds_read_b64_tr_b16 v[54:55], v38 offset:18944
    v_mfma_f32_32x32x16_bf16 v[64:79], v[60:63], a[56:59], v[64:79]
    buffer_load_dwordx4 v26, s[16:19], s41 offen offset:2048 lds
    v_mfma_f32_32x32x16_bf16 v[80:95], v[60:63], a[60:63], v[80:95]
    buffer_load_dwordx4 v27, s[16:19], s41 offen offset:3072 lds
    s_waitcnt lgkmcnt(0)
    v_mfma_f32_32x32x16_bf16 v[64:79], v[48:51], a[64:67], v[64:79]
    ds_read_b64_tr_b16 v[56:57], v38 offset:20480
    ds_read_b64_tr_b16 v[58:59], v38 offset:20992
    v_mfma_f32_32x32x16_bf16 v[80:95], v[48:51], a[68:71], v[80:95]
    ds_read_b64_tr_b16 v[60:61], v38 offset:22528
    ds_read_b64_tr_b16 v[62:63], v38 offset:23040
    v_mfma_f32_32x32x16_bf16 v[64:79], v[52:55], a[72:75], v[64:79]
    buffer_load_dword v254, v12, s[20:23], s64 offen offset:64 sc1
    buffer_load_dword v14, v15, s[20:23], s66 offen sc1
    v_mfma_f32_32x32x16_bf16 v[80:95], v[52:55], a[76:79], v[80:95]
    s_waitcnt lgkmcnt(0)
    v_mfma_f32_32x32x16_bf16 v[64:79], v[56:59], a[80:83], v[64:79]
    ds_read_b64_tr_b16 v[48:49], v38 offset:24576
    ds_read_b64_tr_b16 v[50:51], v38 offset:25088
    v_mfma_f32_32x32x16_bf16 v[80:95], v[56:59], a[84:87], v[80:95]
    ds_read_b64_tr_b16 v[52:53], v38 offset:26624
    ds_read_b64_tr_b16 v[54:55], v38 offset:27136
    v_mfma_f32_32x32x16_bf16 v[64:79], v[60:63], a[88:91], v[64:79]
    v_mfma_f32_32x32x16_bf16 v[80:95], v[60:63], a[92:95], v[80:95]
    s_waitcnt lgkmcnt(0)
    v_mfma_f32_32x32x16_bf16 v[64:79], v[48:51], a[96:99], v[64:79]
    ds_read_b64_tr_b16 v[56:57], v38 offset:28672
    ds_read_b64_tr_b16 v[58:59], v38 offset:29184
    v_mfma_f32_32x32x16_bf16 v[80:95], v[48:51], a[100:103], v[80:95]
    ds_read_b64_tr_b16 v[60:61], v38 offset:30720
    ds_read_b64_tr_b16 v[62:63], v38 offset:31232
    v_mfma_f32_32x32x16_bf16 v[64:79], v[52:55], a[104:107], v[64:79]
    buffer_load_dwordx4 v[96:99], v45, s[20:23], s74 offen sc1
    v_mfma_f32_32x32x16_bf16 v[80:95], v[52:55], a[108:111], v[80:95]
    buffer_load_dwordx4 v[100:103], v45, s[20:23], s75 offen sc1
    s_waitcnt lgkmcnt(0)
    v_mfma_f32_32x32x16_bf16 v[64:79], v[56:59], a[112:115], v[64:79]
    ds_read_b64_tr_b16 v[48:49], v36 offset:0
    ds_read_b64_tr_b16 v[50:51], v36 offset:512
    v_mfma_f32_32x32x16_bf16 v[80:95], v[56:59], a[116:119], v[80:95]
    ds_read_b64_tr_b16 v[52:53], v36 offset:2048
    ds_read_b64_tr_b16 v[54:55], v36 offset:2560
    v_mfma_f32_32x32x16_bf16 v[64:79], v[60:63], a[120:123], v[64:79]
    buffer_load_dwordx4 v[112:115], v46, s[20:23], s74 offen offset:512 sc1
    v_mfma_f32_32x32x16_bf16 v[80:95], v[60:63], a[124:127], v[80:95]
    s_waitcnt lgkmcnt(0)
    v_mfma_f32_32x32x16_bf16 v[64:79], v[48:51], a[128:131], v[64:79]
    ds_read_b64_tr_b16 v[56:57], v36 offset:4096
    ds_read_b64_tr_b16 v[58:59], v36 offset:4608
    v_mfma_f32_32x32x16_bf16 v[80:95], v[48:51], a[132:135], v[80:95]
    ds_read_b64_tr_b16 v[60:61], v36 offset:6144
    ds_read_b64_tr_b16 v[62:63], v36 offset:6656
    v_mfma_f32_32x32x16_bf16 v[64:79], v[52:55], a[136:139], v[64:79]
    v_mfma_f32_32x32x16_bf16 v[80:95], v[52:55], a[140:143], v[80:95]
    s_waitcnt lgkmcnt(0)
    v_mfma_f32_32x32x16_bf16 v[64:79], v[56:59], a[144:147], v[64:79]
    ds_read_b64_tr_b16 v[48:49], v36 offset:8192
    ds_read_b64_tr_b16 v[50:51], v36 offset:8704
    v_mfma_f32_32x32x16_bf16 v[80:95], v[56:59], a[148:151], v[80:95]
    ds_read_b64_tr_b16 v[52:53], v36 offset:10240
    ds_read_b64_tr_b16 v[54:55], v36 offset:10752
    v_mfma_f32_32x32x16_bf16 v[64:79], v[60:63], a[152:155], v[64:79]
    v_mfma_f32_32x32x16_bf16 v[80:95], v[60:63], a[156:159], v[80:95]
    s_waitcnt lgkmcnt(0)
    v_mfma_f32_32x32x16_bf16 v[64:79], v[48:51], a[160:163], v[64:79]
    ds_read_b64_tr_b16 v[56:57], v36 offset:12288
    ds_read_b64_tr_b16 v[58:59], v36 offset:12800
    v_mfma_f32_32x32x16_bf16 v[80:95], v[48:51], a[164:167], v[80:95]
    ds_read_b64_tr_b16 v[60:61], v36 offset:14336
    ds_read_b64_tr_b16 v[62:63], v36 offset:14848
    v_mfma_f32_32x32x16_bf16 v[64:79], v[52:55], a[168:171], v[64:79]
    v_mfma_f32_32x32x16_bf16 v[80:95], v[52:55], a[172:175], v[80:95]
    s_getreg_b32 s37, hwreg(HW_REG_IB_STS, 0, 4)
    s_or_b32 s37, s37, s83
    s_cbranch_scc1 L_sk_25
    s_call_b64 s[38:39], L_try1a
L_sk_25:
    s_waitcnt lgkmcnt(0)
    v_mfma_f32_32x32x16_bf16 v[64:79], v[56:59], a[176:179], v[64:79]
    ds_read_b64_tr_b16 v[48:49], v36 offset:16384
    ds_read_b64_tr_b16 v[50:51], v36 offset:16896
    v_mfma_f32_32x32x16_bf16 v[80:95], v[56:59], a[180:183], v[80:95]
    ds_read_b64_tr_b16 v[52:53], v36 offset:18432
    ds_read_b64_tr_b16 v[54:55], v36 offset:18944
    v_mfma_f32_32x32x16_bf16 v[64:79], v[60:63], a[184:187], v[64:79]
    v_mfma_f32_32x32x16_bf16 v[80:95], v[60:63], a[188:191], v[80:95]
    s_getreg_b32 s37, hwreg(HW_REG_IB_STS, 0, 4)
    s_or_b32 s37, s37, s83
    s_cbranch_scc1 L_sk_26
    s_call_b64 s[38:39], L_try1a
L_sk_26:
    s_waitcnt lgkmcnt(0)
    v_mfma_f32_32x32x16_bf16 v[64:79], v[48:51], a[192:195], v[64:79]
    ds_read_b64_tr_b16 v[56:57], v36 offset:20480
    ds_read_b64_tr_b16 v[58:59], v36 offset:20992
    v_mfma_f32_32x32x16_bf16 v[80:95], v[48:51], a[196:199], v[80:95]
    ds_read_b64_tr_b16 v[60:61], v36 offset:22528
    ds_read_b64_tr_b16 v[62:63], v36 offset:23040
    v_mfma_f32_32x32x16_bf16 v[64:79], v[52:55], a[200:203], v[64:79]
    v_mfma_f32_32x32x16_bf16 v[80:95], v[52:55], a[204:207], v[80:95]
    s_getreg_b32 s37, hwreg(HW_REG_IB_STS, 0, 4)
    s_or_b32 s37, s37, s83
    s_cbranch_scc1 L_sk_27
    s_call_b64 s[38:39], L_try1a
L_sk_27:
    s_waitcnt lgkmcnt(0)
    v_mfma_f32_32x32x16_bf16 v[64:79], v[56:59], a[208:211], v[64:79]
    ds_read_b64_tr_b16 v[48:49], v36 offset:24576
    ds_read_b64_tr_b16 v[50:51], v36 offset:25088
    v_mfma_f32_32x32x16_bf16 v[80:95], v[56:59], a[212:215], v[80:95]
    ds_read_b64_tr_b16 v[52:53], v36 offset:26624
    ds_read_b64_tr_b16 v[54:55], v36 offset:27136
    v_mfma_f32_32x32x16_bf16 v[64:79], v[60:63], a[216:219], v[64:79]
    v_mfma_f32_32x32x16_bf16 v[80:95], v[60:63], a[220:223], v[80:95]
    s_getreg_b32 s37, hwreg(HW_REG_IB_STS, 0, 4)
    s_or_b32 s37, s37, s83
    s_cbranch_scc1 L_sk_28
    s_call_b64 s[38:39], L_try1a
L_sk_28:
    s_waitcnt lgkmcnt(0)
    v_mfma_f32_32x32x16_bf16 v[64:79], v[48:51], a[224:227], v[64:79]
    ds_read_b64_tr_b16 v[56:57], v36 offset:28672
    ds_read_b64_tr_b16 v[58:59], v36 offset:29184
    v_mfma_f32_32x32x16_bf16 v[80:95], v[48:51], a[228:231], v[80:95]
    ds_read_b64_tr_b16 v[60:61], v36 offset:30720
    ds_read_b64_tr_b16 v[62:63], v36 offset:31232
    v_mfma_f32_32x32x16_bf16 v[64:79], v[52:55], a[232:235], v[64:79]
    v_mfma_f32_32x32x16_bf16 v[80:95], v[52:55], a[236:239], v[80:95]
    s_getreg_b32 s37, hwreg(HW_REG_IB_STS, 0, 4)
    s_or_b32 s37, s37, s83
    s_cbranch_scc1 L_sk_29
    s_call_b64 s[38:39], L_try1a
L_sk_29:
    s_waitcnt lgkmcnt(0)
    v_mfma_f32_32x32x16_bf16 v[64:79], v[56:59], a[240:243], v[64:79]
    v_mfma_f32_32x32x16_bf16 v[64:79], v[60:63], a[248:251], v[64:79]
    v_mfma_f32_32x32x16_bf16 v[80:95], v[56:59], a[244:247], v[80:95]
    v_mfma_f32_32x32x16_bf16 v[80:95], v[60:63], a[252:255], v[80:95]
    s_getreg_b32 s37, hwreg(HW_REG_IB_STS, 0, 4)
    s_or_b32 s37, s37, s83
    s_cbranch_scc1 L_sk_30
    s_call_b64 s[38:39], L_try1a
L_sk_30:
    s_nop 6
    v_cvt_pk_bf16_f32 v64, v64, v65
    v_cvt_pk_bf16_f32 v65, v66, v67
    v_cvt_pk_bf16_f32 v66, v68, v69
    v_cvt_pk_bf16_f32 v67, v70, v71
    v_cvt_pk_bf16_f32 v68, v72, v73
    v_cvt_pk_bf16_f32 v69, v74, v75
    v_cvt_pk_bf16_f32 v70, v76, v77
    v_cvt_pk_bf16_f32 v71, v78, v79
    v_mfma_f32_32x32x16_bf16 v[128:143], v[224:227], v[64:67], 0
    s_nop 0
    v_mfma_f32_32x32x16_bf16 v[144:159], v[228:231], v[68:71], 0
    v_cvt_pk_bf16_f32 v80, v80, v81
    v_cvt_pk_bf16_f32 v81, v82, v83
    v_cvt_pk_bf16_f32 v82, v84, v85
    v_cvt_pk_bf16_f32 v83, v86, v87
    v_cvt_pk_bf16_f32 v84, v88, v89
    v_cvt_pk_bf16_f32 v85, v90, v91
    v_cvt_pk_bf16_f32 v86, v92, v93
    v_cvt_pk_bf16_f32 v87, v94, v95
    v_mfma_f32_32x32x16_bf16 v[160:175], v[224:227], v[80:83], 0
    s_nop 0
    v_mfma_f32_32x32x16_bf16 v[176:191], v[228:231], v[84:87], 0
    s_mov_b32 s56, 16384
L_w1a_31:
    s_cmp_lg_u32 s83, 0
    s_cbranch_scc1 L_sk_33
    s_call_b64 s[38:39], L_try1a
L_sk_33:
    s_cmp_lg_u32 s83, 0
    s_cbranch_scc1 L_w1d_32
    s_sub_u32 s56, s56, 1
    s_cbranch_scc0 L_w1a_31
L_w1d_32:
    s_mov_b32 s36, 0
    v_max3_f32 v232, v128, v129, v130
    v_max3_f32 v232, v232, v131, v132
    v_max3_f32 v232, v232, v133, v134
    v_max3_f32 v232, v232, v135, v136
    v_max3_f32 v232, v232, v137, v138
    v_max3_f32 v232, v232, v139, v140
    v_max3_f32 v232, v232, v141, v142
    v_max_f32_e64 v232, v232, v143
    v_mul_f32 v232, s54, v232
    v_pk_fma_f32 v[128:129], v[128:129], s[54:55], v[232:233] op_sel_hi:[1,1,0] neg_lo:[0,0,1] neg_hi:[0,0,1]
    v_pk_fma_f32 v[130:131], v[130:131], s[54:55], v[232:233] op_sel_hi:[1,1,0] neg_lo:[0,0,1] neg_hi:[0,0,1]
    v_pk_fma_f32 v[132:133], v[132:133], s[54:55], v[232:233] op_sel_hi:[1,1,0] neg_lo:[0,0,1] neg_hi:[0,0,1]
    v_pk_fma_f32 v[134:135], v[134:135], s[54:55], v[232:233] op_sel_hi:[1,1,0] neg_lo:[0,0,1] neg_hi:[0,0,1]
    v_pk_fma_f32 v[136:137], v[136:137], s[54:55], v[232:233] op_sel_hi:[1,1,0] neg_lo:[0,0,1] neg_hi:[0,0,1]
    v_pk_fma_f32 v[138:139], v[138:139], s[54:55], v[232:233] op_sel_hi:[1,1,0] neg_lo:[0,0,1] neg_hi:[0,0,1]
    v_pk_fma_f32 v[140:141], v[140:141], s[54:55], v[232:233] op_sel_hi:[1,1,0] neg_lo:[0,0,1] neg_hi:[0,0,1]
    v_pk_fma_f32 v[142:143], v[142:143], s[54:55], v[232:233] op_sel_hi:[1,1,0] neg_lo:[0,0,1] neg_hi:[0,0,1]
    v_exp_f32 v128, v128
    v_exp_f32 v129, v129
    v_exp_f32 v130, v130
    v_exp_f32 v131, v131
    v_exp_f32 v132, v132
    v_exp_f32 v133, v133
    v_exp_f32 v134, v134
    v_exp_f32 v135, v135
    v_exp_f32 v136, v136
    v_exp_f32 v137, v137
    v_exp_f32 v138, v138
    v_exp_f32 v139, v139
    v_exp_f32 v140, v140
    v_exp_f32 v141, v141
    v_exp_f32 v142, v142
    v_exp_f32 v143, v143
    v_pk_add_f32 v[234:235], v[128:129], v[130:131]
    v_pk_add_f32 v[234:235], v[234:235], v[132:133]
    v_pk_add_f32 v[234:235], v[234:235], v[134:135]
    v_pk_add_f32 v[234:235], v[234:235], v[136:137]
    v_pk_add_f32 v[234:235], v[234:235], v[138:139]
    v_pk_add_f32 v[234:235], v[234:235], v[140:141]
    v_pk_add_f32 v[234:235], v[234:235], v[142:143]
    v_add_f32_e64 v234, v234, v235
    v_rcp_f32 v234, v234
    s_nop 0
    v_pk_mul_f32 v[128:129], v[128:129], v[234:235] op_sel_hi:[1,0]
    v_pk_mul_f32 v[130:131], v[130:131], v[234:235] op_sel_hi:[1,0]
    v_pk_mul_f32 v[132:133], v[132:133], v[234:235] op_sel_hi:[1,0]
    v_pk_mul_f32 v[134:135], v[134:135], v[234:235] op_sel_hi:[1,0]
    v_pk_mul_f32 v[136:137], v[136:137], v[234:235] op_sel_hi:[1,0]
    v_pk_mul_f32 v[138:139], v[138:139], v[234:235] op_sel_hi:[1,0]
    v_pk_mul_f32 v[140:141], v[140:141], v[234:235] op_sel_hi:[1,0]
    v_pk_mul_f32 v[142:143], v[142:143], v[234:235] op_sel_hi:[1,0]
    v_cvt_pk_bf16_f32 v192, v128, v129
    v_cvt_pk_bf16_f32 v193, v130, v131
    v_cvt_pk_bf16_f32 v194, v132, v133
    v_cvt_pk_bf16_f32 v195, v134, v135
    v_cvt_pk_bf16_f32 v196, v136, v137
    v_cvt_pk_bf16_f32 v197, v138, v139
    v_cvt_pk_bf16_f32 v198, v140, v141
    v_cvt_pk_bf16_f32 v199, v142, v143
    v_max3_f32 v232, v144, v145, v146
    v_max3_f32 v232, v232, v147, v148
    v_max3_f32 v232, v232, v149, v150
    v_max3_f32 v232, v232, v151, v152
    v_max3_f32 v232, v232, v153, v154
    v_max3_f32 v232, v232, v155, v156
    v_max3_f32 v232, v232, v157, v158
    v_max_f32 v232, v232, v159
    v_mul_f32 v232, s54, v232
    v_pk_fma_f32 v[144:145], v[144:145], s[54:55], v[232:233] op_sel_hi:[1,1,0] neg_lo:[0,0,1] neg_hi:[0,0,1]
    v_pk_fma_f32 v[146:147], v[146:147], s[54:55], v[232:233] op_sel_hi:[1,1,0] neg_lo:[0,0,1] neg_hi:[0,0,1]
    v_pk_fma_f32 v[148:149], v[148:149], s[54:55], v[232:233] op_sel_hi:[1,1,0] neg_lo:[0,0,1] neg_hi:[0,0,1]
    v_pk_fma_f32 v[150:151], v[150:151], s[54:55], v[232:233] op_sel_hi:[1,1,0] neg_lo:[0,0,1] neg_hi:[0,0,1]
    v_pk_fma_f32 v[152:153], v[152:153], s[54:55], v[232:233] op_sel_hi:[1,1,0] neg_lo:[0,0,1] neg_hi:[0,0,1]
    v_pk_fma_f32 v[154:155], v[154:155], s[54:55], v[232:233] op_sel_hi:[1,1,0] neg_lo:[0,0,1] neg_hi:[0,0,1]
    v_pk_fma_f32 v[156:157], v[156:157], s[54:55], v[232:233] op_sel_hi:[1,1,0] neg_lo:[0,0,1] neg_hi:[0,0,1]
    v_pk_fma_f32 v[158:159], v[158:159], s[54:55], v[232:233] op_sel_hi:[1,1,0] neg_lo:[0,0,1] neg_hi:[0,0,1]
    v_exp_f32 v144, v144
    v_exp_f32 v145, v145
    v_exp_f32 v146, v146
    v_exp_f32 v147, v147
    v_exp_f32 v148, v148
    v_exp_f32 v149, v149
    v_exp_f32 v150, v150
    v_exp_f32 v151, v151
    v_exp_f32 v152, v152
    v_exp_f32 v153, v153
    v_exp_f32 v154, v154
    v_exp_f32 v155, v155
    v_exp_f32 v156, v156
    v_exp_f32 v157, v157
    v_exp_f32 v158, v158
    v_exp_f32 v159, v159
    v_pk_add_f32 v[234:235], v[144:145], v[146:147]
    v_pk_add_f32 v[234:235], v[234:235], v[148:149]
    v_pk_add_f32 v[234:235], v[234:235], v[150:151]
    v_pk_add_f32 v[234:235], v[234:235], v[152:153]
    v_pk_add_f32 v[234:235], v[234:235], v[154:155]
    v_pk_add_f32 v[234:235], v[234:235], v[156:157]
    v_pk_add_f32 v[234:235], v[234:235], v[158:159]
    v_add_f32_e64 v234, v234, v235
    v_rcp_f32 v234, v234
    s_nop 0
    v_pk_mul_f32 v[144:145], v[144:145], v[234:235] op_sel_hi:[1,0]
    v_pk_mul_f32 v[146:147], v[146:147], v[234:235] op_sel_hi:[1,0]
    v_pk_mul_f32 v[148:149], v[148:149], v[234:235] op_sel_hi:[1,0]
    v_pk_mul_f32 v[150:151], v[150:151], v[234:235] op_sel_hi:[1,0]
    v_pk_mul_f32 v[152:153], v[152:153], v[234:235] op_sel_hi:[1,0]
    v_pk_mul_f32 v[154:155], v[154:155], v[234:235] op_sel_hi:[1,0]
    v_pk_mul_f32 v[156:157], v[156:157], v[234:235] op_sel_hi:[1,0]
    v_pk_mul_f32 v[158:159], v[158:159], v[234:235] op_sel_hi:[1,0]
    v_cvt_pk_bf16_f32 v200, v144, v145
    v_cvt_pk_bf16_f32 v201, v146, v147
    v_cvt_pk_bf16_f32 v202, v148, v149
    v_cvt_pk_bf16_f32 v203, v150, v151
    v_cvt_pk_bf16_f32 v204, v152, v153
    v_cvt_pk_bf16_f32 v205, v154, v155
    v_cvt_pk_bf16_f32 v206, v156, v157
    v_cvt_pk_bf16_f32 v207, v158, v159
    v_max3_f32 v232, v160, v161, v162
    v_max3_f32 v232, v232, v163, v164
    v_max3_f32 v232, v232, v165, v166
    v_max3_f32 v232, v232, v167, v168
    v_max3_f32 v232, v232, v169, v170
    v_max3_f32 v232, v232, v171, v172
    v_max3_f32 v232, v232, v173, v174
    v_max_f32 v232, v232, v175
    v_mul_f32 v232, s54, v232
    v_pk_fma_f32 v[160:161], v[160:161], s[54:55], v[232:233] op_sel_hi:[1,1,0] neg_lo:[0,0,1] neg_hi:[0,0,1]
    v_pk_fma_f32 v[162:163], v[162:163], s[54:55], v[232:233] op_sel_hi:[1,1,0] neg_lo:[0,0,1] neg_hi:[0,0,1]
    v_pk_fma_f32 v[164:165], v[164:165], s[54:55], v[232:233] op_sel_hi:[1,1,0] neg_lo:[0,0,1] neg_hi:[0,0,1]
    v_pk_fma_f32 v[166:167], v[166:167], s[54:55], v[232:233] op_sel_hi:[1,1,0] neg_lo:[0,0,1] neg_hi:[0,0,1]
    v_pk_fma_f32 v[168:169], v[168:169], s[54:55], v[232:233] op_sel_hi:[1,1,0] neg_lo:[0,0,1] neg_hi:[0,0,1]
    v_pk_fma_f32 v[170:171], v[170:171], s[54:55], v[232:233] op_sel_hi:[1,1,0] neg_lo:[0,0,1] neg_hi:[0,0,1]
    v_pk_fma_f32 v[172:173], v[172:173], s[54:55], v[232:233] op_sel_hi:[1,1,0] neg_lo:[0,0,1] neg_hi:[0,0,1]
    v_pk_fma_f32 v[174:175], v[174:175], s[54:55], v[232:233] op_sel_hi:[1,1,0] neg_lo:[0,0,1] neg_hi:[0,0,1]
    v_exp_f32 v160, v160
    v_exp_f32 v161, v161
    v_exp_f32 v162, v162
    v_exp_f32 v163, v163
    v_exp_f32 v164, v164
    v_exp_f32 v165, v165
    v_exp_f32 v166, v166
    v_exp_f32 v167, v167
    v_exp_f32 v168, v168
    v_exp_f32 v169, v169
    v_exp_f32 v170, v170
    v_exp_f32 v171, v171
    v_exp_f32 v172, v172
    v_exp_f32 v173, v173
    v_exp_f32 v174, v174
    v_exp_f32 v175, v175
    v_pk_add_f32 v[234:235], v[160:161], v[162:163]
    v_pk_add_f32 v[234:235], v[234:235], v[164:165]
    v_pk_add_f32 v[234:235], v[234:235], v[166:167]
    v_pk_add_f32 v[234:235], v[234:235], v[168:169]
    v_pk_add_f32 v[234:235], v[234:235], v[170:171]
    v_pk_add_f32 v[234:235], v[234:235], v[172:173]
    v_pk_add_f32 v[234:235], v[234:235], v[174:175]
    v_add_f32_e64 v234, v234, v235
    v_rcp_f32 v234, v234
    s_nop 0
    v_pk_mul_f32 v[160:161], v[160:161], v[234:235] op_sel_hi:[1,0]
    v_pk_mul_f32 v[162:163], v[162:163], v[234:235] op_sel_hi:[1,0]
    v_pk_mul_f32 v[164:165], v[164:165], v[234:235] op_sel_hi:[1,0]
    v_pk_mul_f32 v[166:167], v[166:167], v[234:235] op_sel_hi:[1,0]
    v_pk_mul_f32 v[168:169], v[168:169], v[234:235] op_sel_hi:[1,0]
    v_pk_mul_f32 v[170:171], v[170:171], v[234:235] op_sel_hi:[1,0]
    v_pk_mul_f32 v[172:173], v[172:173], v[234:235] op_sel_hi:[1,0]
    v_pk_mul_f32 v[174:175], v[174:175], v[234:235] op_sel_hi:[1,0]
    v_cvt_pk_bf16_f32 v208, v160, v161
    v_cvt_pk_bf16_f32 v209, v162, v163
    v_cvt_pk_bf16_f32 v210, v164, v165
    v_cvt_pk_bf16_f32 v211, v166, v167
    v_cvt_pk_bf16_f32 v212, v168, v169
    v_cvt_pk_bf16_f32 v213, v170, v171
    v_cvt_pk_bf16_f32 v214, v172, v173
    v_cvt_pk_bf16_f32 v215, v174, v175
    buffer_load_dwordx4 v[128:131], v47, s[20:23], s81 offen offset:0 sc1
    buffer_load_dwordx4 v[132:135], v42, s[20:23], s81 offen offset:0 sc1
    buffer_load_dwordx4 v[136:139], v47, s[20:23], s81 offen offset:640 sc1
    buffer_load_dwordx4 v[140:143], v42, s[20:23], s81 offen offset:640 sc1
    buffer_load_dwordx4 v[144:147], v47, s[20:23], s81 offen offset:2560 sc1
    buffer_load_dwordx4 v[148:151], v42, s[20:23], s81 offen offset:2560 sc1
    buffer_load_dwordx4 v[152:155], v47, s[20:23], s81 offen offset:3200 sc1
    buffer_load_dwordx4 v[156:159], v42, s[20:23], s81 offen offset:3200 sc1
    v_max3_f32 v232, v176, v177, v178
    v_max3_f32 v232, v232, v179, v180
    v_max3_f32 v232, v232, v181, v182
    v_max3_f32 v232, v232, v183, v184
    v_max3_f32 v232, v232, v185, v186
    v_max3_f32 v232, v232, v187, v188
    v_max3_f32 v232, v232, v189, v190
    v_max_f32 v232, v232, v191
    v_mul_f32 v232, s54, v232
    v_pk_fma_f32 v[176:177], v[176:177], s[54:55], v[232:233] op_sel_hi:[1,1,0] neg_lo:[0,0,1] neg_hi:[0,0,1]
    v_pk_fma_f32 v[178:179], v[178:179], s[54:55], v[232:233] op_sel_hi:[1,1,0] neg_lo:[0,0,1] neg_hi:[0,0,1]
    v_pk_fma_f32 v[180:181], v[180:181], s[54:55], v[232:233] op_sel_hi:[1,1,0] neg_lo:[0,0,1] neg_hi:[0,0,1]
    v_pk_fma_f32 v[182:183], v[182:183], s[54:55], v[232:233] op_sel_hi:[1,1,0] neg_lo:[0,0,1] neg_hi:[0,0,1]
    v_pk_fma_f32 v[184:185], v[184:185], s[54:55], v[232:233] op_sel_hi:[1,1,0] neg_lo:[0,0,1] neg_hi:[0,0,1]
    v_pk_fma_f32 v[186:187], v[186:187], s[54:55], v[232:233] op_sel_hi:[1,1,0] neg_lo:[0,0,1] neg_hi:[0,0,1]
    v_pk_fma_f32 v[188:189], v[188:189], s[54:55], v[232:233] op_sel_hi:[1,1,0] neg_lo:[0,0,1] neg_hi:[0,0,1]
    v_pk_fma_f32 v[190:191], v[190:191], s[54:55], v[232:233] op_sel_hi:[1,1,0] neg_lo:[0,0,1] neg_hi:[0,0,1]
    v_exp_f32 v176, v176
    v_exp_f32 v177, v177
    v_exp_f32 v178, v178
    v_exp_f32 v179, v179
    v_exp_f32 v180, v180
    v_exp_f32 v181, v181
    v_exp_f32 v182, v182
    v_exp_f32 v183, v183
    v_exp_f32 v184, v184
    v_exp_f32 v185, v185
    v_exp_f32 v186, v186
    v_exp_f32 v187, v187
    v_exp_f32 v188, v188
    v_exp_f32 v189, v189
    v_exp_f32 v190, v190
    v_exp_f32 v191, v191
    v_pk_add_f32 v[234:235], v[176:177], v[178:179]
    v_pk_add_f32 v[234:235], v[234:235], v[180:181]
    v_pk_add_f32 v[234:235], v[234:235], v[182:183]
    v_pk_add_f32 v[234:235], v[234:235], v[184:185]
    v_pk_add_f32 v[234:235], v[234:235], v[186:187]
    v_pk_add_f32 v[234:235], v[234:235], v[188:189]
    v_pk_add_f32 v[234:235], v[234:235], v[190:191]
    v_add_f32_e64 v234, v234, v235
    v_rcp_f32 v234, v234
    s_nop 0
    v_pk_mul_f32 v[176:177], v[176:177], v[234:235] op_sel_hi:[1,0]
    v_pk_mul_f32 v[178:179], v[178:179], v[234:235] op_sel_hi:[1,0]
    v_pk_mul_f32 v[180:181], v[180:181], v[234:235] op_sel_hi:[1,0]
    v_pk_mul_f32 v[182:183], v[182:183], v[234:235] op_sel_hi:[1,0]
    v_pk_mul_f32 v[184:185], v[184:185], v[234:235] op_sel_hi:[1,0]
    v_pk_mul_f32 v[186:187], v[186:187], v[234:235] op_sel_hi:[1,0]
    v_pk_mul_f32 v[188:189], v[188:189], v[234:235] op_sel_hi:[1,0]
    v_pk_mul_f32 v[190:191], v[190:191], v[234:235] op_sel_hi:[1,0]
    v_cvt_pk_bf16_f32 v216, v176, v177
    v_cvt_pk_bf16_f32 v217, v178, v179
    v_cvt_pk_bf16_f32 v218, v180, v181
    v_cvt_pk_bf16_f32 v219, v182, v183
    v_cvt_pk_bf16_f32 v220, v184, v185
    v_cvt_pk_bf16_f32 v221, v186, v187
    v_cvt_pk_bf16_f32 v222, v188, v189
    v_cvt_pk_bf16_f32 v223, v190, v191
    s_barrier
    s_lshl_b32 s37, s28, 12
    v_add_u32_e64 v28, s37, v7
    v_add_u32 v29, 0x10000, v28
    v_add_u32 v30, 0x20000, v28
    s_lshl_b32 s37, s90, 13
    s_add_u32 s37, s37, s49
    s_add_u32 s37, s37, 0x18000
    v_add_u32_e64 v31, s37, v7
    v_xor_b32 v32, 0x2000, v31
    ds_read_b64_tr_b16 a[0:1], v36 offset:49152
    ds_read_b64_tr_b16 a[2:3], v36 offset:49664
    ds_read_b64_tr_b16 a[4:5], v36 offset:51200
    ds_read_b64_tr_b16 a[6:7], v36 offset:51712
    ds_read_b64_tr_b16 a[8:9], v36 offset:53248
    ds_read_b64_tr_b16 a[10:11], v36 offset:53760
    ds_read_b64_tr_b16 a[12:13], v36 offset:55296
    ds_read_b64_tr_b16 a[14:15], v36 offset:55808
    s_mov_b32 s56, 16384
L_poll_34:
    s_waitcnt vmcnt(0)
    v_cvt_pk_bf16_f32 v112, v128, v129
    v_cvt_pk_bf16_f32 v113, v130, v131
    v_cvt_pk_bf16_f32 v114, v132, v133
    v_cvt_pk_bf16_f32 v115, v134, v135
    v_cvt_pk_bf16_f32 v116, v136, v137
    v_cvt_pk_bf16_f32 v117, v138, v139
    v_cvt_pk_bf16_f32 v118, v140, v141
    v_cvt_pk_bf16_f32 v119, v142, v143
    v_mfma_f32_32x32x16_bf16 v[64:79], v[112:115], v[192:195], 0
    v_xor_b32 v13, v128, v8
    v_bitop3_b32 v13, v132, v8, v13 bitop3:0xbe
    v_bitop3_b32 v13, v136, v8, v13 bitop3:0xbe
    v_mfma_f32_32x32x16_bf16 v[64:79], v[116:119], v[196:199], v[64:79]
    v_bitop3_b32 v13, v140, v8, v13 bitop3:0xbe
    v_bitop3_b32 v13, v144, v8, v13 bitop3:0xbe
    v_bitop3_b32 v13, v148, v8, v13 bitop3:0xbe
    v_mfma_f32_32x32x16_bf16 v[160:175], v[112:115], v[208:211], 0
    v_bitop3_b32 v13, v152, v8, v13 bitop3:0xbe
    v_bitop3_b32 v13, v156, v8, v13 bitop3:0xbe
    v_mfma_f32_32x32x16_bf16 v[160:175], v[116:119], v[212:215], v[160:175]
    v_cvt_pk_bf16_f32 v120, v144, v145
    v_cvt_pk_bf16_f32 v121, v146, v147
    v_cvt_pk_bf16_f32 v122, v148, v149
    v_cvt_pk_bf16_f32 v123, v150, v151
    v_cvt_pk_bf16_f32 v124, v152, v153
    v_cvt_pk_bf16_f32 v125, v154, v155
    v_cvt_pk_bf16_f32 v126, v156, v157
    v_cvt_pk_bf16_f32 v127, v158, v159
    v_mfma_f32_32x32x16_bf16 v[80:95], v[120:123], v[200:203], 0
    s_nop 0
    v_mfma_f32_32x32x16_bf16 v[80:95], v[124:127], v[204:207], v[80:95]
    v_mfma_f32_32x32x16_bf16 v[176:191], v[120:123], v[216:219], 0
    v_mfma_f32_32x32x16_bf16 v[176:191], v[124:127], v[220:223], v[176:191]
    v_xor_b32 v14, s91, v14
    v_lshrrev_b32 v9, 4, v14
    v_and_b32 v13, 0xff, v13
    v_or_b32 v13, v13, v9
    v_cmp_ne_u32 s[58:59], 0, v13
    s_nop 0
    s_cmp_eq_u64 s[58:59], 0
    s_cbranch_scc1 L_ok_35
    buffer_load_dwordx4 v[128:131], v47, s[20:23], s81 offen offset:0 sc1
    buffer_load_dwordx4 v[132:135], v42, s[20:23], s81 offen offset:0 sc1
    buffer_load_dwordx4 v[136:139], v47, s[20:23], s81 offen offset:640 sc1
    buffer_load_dwordx4 v[140:143], v42, s[20:23], s81 offen offset:640 sc1
    buffer_load_dwordx4 v[144:147], v47, s[20:23], s81 offen offset:2560 sc1
    buffer_load_dwordx4 v[148:151], v42, s[20:23], s81 offen offset:2560 sc1
    buffer_load_dwordx4 v[152:155], v47, s[20:23], s81 offen offset:3200 sc1
    buffer_load_dwordx4 v[156:159], v42, s[20:23], s81 offen offset:3200 sc1
    buffer_load_dword v254, v12, s[20:23], s64 offen offset:64 sc1
    buffer_load_dword v14, v15, s[20:23], s66 offen sc1
    s_sub_u32 s56, s56, 1
    s_cbranch_scc0 L_poll_34
    s_waitcnt vmcnt(0)
L_ok_35:
    v_add_f32 v72, 0x358637bd, v72
    v_rcp_f32 v72, v72
    s_nop 0
    v_pk_mul_f32 v[64:65], v[64:65], v[72:73] op_sel_hi:[1,0]
    v_pk_mul_f32 v[66:67], v[66:67], v[72:73] op_sel_hi:[1,0]
    v_pk_mul_f32 v[68:69], v[68:69], v[72:73] op_sel_hi:[1,0]
    v_pk_mul_f32 v[70:71], v[70:71], v[72:73] op_sel_hi:[1,0]
    v_cvt_pk_bf16_f32 v76, v64, v65
    v_cvt_pk_bf16_f32 v77, v66, v67
    v_cvt_pk_bf16_f32 v78, v68, v69
    v_cvt_pk_bf16_f32 v79, v70, v71
    buffer_store_dwordx4 v[76:79], v7, s[20:23], s88 offen offset:0 sc1
    v_add_f32 v168, 0x358637bd, v168
    v_rcp_f32 v168, v168
    s_nop 0
    v_pk_mul_f32 v[160:161], v[160:161], v[168:169] op_sel_hi:[1,0]
    v_pk_mul_f32 v[162:163], v[162:163], v[168:169] op_sel_hi:[1,0]
    v_pk_mul_f32 v[164:165], v[164:165], v[168:169] op_sel_hi:[1,0]
    v_pk_mul_f32 v[166:167], v[166:167], v[168:169] op_sel_hi:[1,0]
    v_cvt_pk_bf16_f32 v172, v160, v161
    v_cvt_pk_bf16_f32 v173, v162, v163
    v_cvt_pk_bf16_f32 v174, v164, v165
    v_cvt_pk_bf16_f32 v175, v166, v167
    buffer_store_dwordx4 v[172:175], v7, s[20:23], s89 offen offset:0 sc1
    v_add_f32 v88, 0x358637bd, v88
    v_rcp_f32 v88, v88
    s_nop 0
    v_pk_mul_f32 v[80:81], v[80:81], v[88:89] op_sel_hi:[1,0]
    v_pk_mul_f32 v[82:83], v[82:83], v[88:89] op_sel_hi:[1,0]
    v_pk_mul_f32 v[84:85], v[84:85], v[88:89] op_sel_hi:[1,0]
    v_pk_mul_f32 v[86:87], v[86:87], v[88:89] op_sel_hi:[1,0]
    v_cvt_pk_bf16_f32 v92, v80, v81
    v_cvt_pk_bf16_f32 v93, v82, v83
    v_cvt_pk_bf16_f32 v94, v84, v85
    v_cvt_pk_bf16_f32 v95, v86, v87
    buffer_store_dwordx4 v[92:95], v7, s[20:23], s88 offen offset:1024 sc1
    v_add_f32 v184, 0x358637bd, v184
    v_rcp_f32 v184, v184
    s_nop 0
    v_pk_mul_f32 v[176:177], v[176:177], v[184:185] op_sel_hi:[1,0]
    v_pk_mul_f32 v[178:179], v[178:179], v[184:185] op_sel_hi:[1,0]
    v_pk_mul_f32 v[180:181], v[180:181], v[184:185] op_sel_hi:[1,0]
    v_pk_mul_f32 v[182:183], v[182:183], v[184:185] op_sel_hi:[1,0]
    v_cvt_pk_bf16_f32 v188, v176, v177
    v_cvt_pk_bf16_f32 v189, v178, v179
    v_cvt_pk_bf16_f32 v190, v180, v181
    v_cvt_pk_bf16_f32 v191, v182, v183
    buffer_store_dwordx4 v[188:191], v7, s[20:23], s89 offen offset:1024 sc1
    v_cmp_ne_u32 vcc, 0, v14
    s_nop 0
    s_cmp_lg_u64 vcc, 0
    s_cselect_b32 s92, 1, 0
    ds_write_b128 v31, v[76:79] offset:0
    ds_write_b128 v31, v[92:95] offset:1024
    ds_write_b128 v32, v[172:175] offset:0
    ds_write_b128 v32, v[188:191] offset:1024
    s_waitcnt lgkmcnt(0)
    s_barrier
    ds_read_b128 v[128:131], v29 offset:32768
    ds_read_b128 v[132:135], v29 offset:33792
    ds_read_b128 v[136:139], v29 offset:34816
    ds_read_b128 v[140:143], v29 offset:35840
    s_waitcnt lgkmcnt(0)
    s_nop 0
    v_mfma_f32_32x32x16_bf16 v[96:111], v[128:131], a[0:3], 0
    ds_read_b128 v[144:147], v29 offset:40960
    ds_read_b128 v[148:151], v29 offset:41984
    v_mfma_f32_32x32x16_bf16 v[96:111], v[132:135], a[4:7], v[96:111]
    ds_read_b128 v[152:155], v29 offset:43008
    ds_read_b128 v[156:159], v29 offset:44032
    v_mfma_f32_32x32x16_bf16 v[96:111], v[136:139], a[8:11], v[96:111]
    ds_read_b64_tr_b16 a[16:17], v36 offset:32768
    ds_read_b64_tr_b16 a[18:19], v36 offset:33280
    v_mfma_f32_32x32x16_bf16 v[96:111], v[140:143], a[12:15], v[96:111]
    ds_read_b64_tr_b16 a[20:21], v36 offset:34816
    ds_read_b64_tr_b16 a[22:23], v36 offset:35328
    s_waitcnt lgkmcnt(0)
    s_nop 0
    v_mfma_f32_32x32x16_bf16 v[112:127], v[144:147], a[0:3], 0
    v_mfma_f32_32x32x16_bf16 v[112:127], v[148:151], a[4:7], v[112:127]
    v_mfma_f32_32x32x16_bf16 v[112:127], v[152:155], a[8:11], v[112:127]
    ds_read_b64_tr_b16 a[24:25], v36 offset:36864
    ds_read_b64_tr_b16 a[26:27], v36 offset:37376
    v_mfma_f32_32x32x16_bf16 v[112:127], v[156:159], a[12:15], v[112:127]
    ds_read_b64_tr_b16 a[28:29], v36 offset:38912
    ds_read_b64_tr_b16 a[30:31], v36 offset:39424
    ds_read_b64_tr_b16 a[32:33], v36 offset:40960
    ds_read_b64_tr_b16 a[34:35], v36 offset:41472
    ds_read_b64_tr_b16 a[36:37], v36 offset:43008
    ds_read_b64_tr_b16 a[38:39], v36 offset:43520
    ds_read_b64_tr_b16 a[40:41], v36 offset:45056
    ds_read_b64_tr_b16 a[42:43], v36 offset:45568
    ds_read_b64_tr_b16 a[44:45], v36 offset:47104
    ds_read_b64_tr_b16 a[46:47], v36 offset:47616
    ds_read_b64_tr_b16 a[48:49], v36 offset:57344
    ds_read_b64_tr_b16 a[50:51], v36 offset:57856
    ds_read_b64_tr_b16 a[52:53], v36 offset:59392
    ds_read_b64_tr_b16 a[54:55], v36 offset:59904
    ds_read_b64_tr_b16 a[56:57], v36 offset:61440
    ds_read_b64_tr_b16 a[58:59], v36 offset:61952
    ds_read_b64_tr_b16 a[60:61], v36 offset:63488
    ds_read_b64_tr_b16 a[62:63], v36 offset:64000
    s_waitcnt vmcnt(0)
    s_cmp_lg_u32 s92, 0
    s_cbranch_scc1 L_slow_36
    s_nop 0
    buffer_store_dword v11, v10, s[20:23], s93 offen offset:0
L_join_37:
    ds_read_b64_tr_b16 a[64:65], v37 offset:0
    ds_read_b64_tr_b16 a[66:67], v37 offset:512
    ds_read_b64_tr_b16 a[68:69], v37 offset:2048
    ds_read_b64_tr_b16 a[70:71], v37 offset:2560
    ds_read_b64_tr_b16 a[72:73], v37 offset:4096
    ds_read_b64_tr_b16 a[74:75], v37 offset:4608
    ds_read_b64_tr_b16 a[76:77], v37 offset:6144
    ds_read_b64_tr_b16 a[78:79], v37 offset:6656
    ds_read_b64_tr_b16 a[80:81], v37 offset:8192
    ds_read_b64_tr_b16 a[82:83], v37 offset:8704
    ds_read_b64_tr_b16 a[84:85], v37 offset:10240
    ds_read_b64_tr_b16 a[86:87], v37 offset:10752
    ds_read_b64_tr_b16 a[88:89], v37 offset:12288
    ds_read_b64_tr_b16 a[90:91], v37 offset:12800
    ds_read_b64_tr_b16 a[92:93], v37 offset:14336
    ds_read_b64_tr_b16 a[94:95], v37 offset:14848
    ds_read_b64_tr_b16 a[96:97], v37 offset:16384
    ds_read_b64_tr_b16 a[98:99], v37 offset:16896
    ds_read_b64_tr_b16 a[100:101], v37 offset:18432
    ds_read_b64_tr_b16 a[102:103], v37 offset:18944
    ds_read_b64_tr_b16 a[104:105], v37 offset:20480
    ds_read_b64_tr_b16 a[106:107], v37 offset:20992
    ds_read_b64_tr_b16 a[108:109], v37 offset:22528
    ds_read_b64_tr_b16 a[110:111], v37 offset:23040
    ds_read_b64_tr_b16 a[112:113], v37 offset:24576
    ds_read_b64_tr_b16 a[114:115], v37 offset:25088
    ds_read_b64_tr_b16 a[116:117], v37 offset:26624
    ds_read_b64_tr_b16 a[118:119], v37 offset:27136
    ds_read_b64_tr_b16 a[120:121], v37 offset:28672
    ds_read_b64_tr_b16 a[122:123], v37 offset:29184
    ds_read_b64_tr_b16 a[124:125], v37 offset:30720
    ds_read_b64_tr_b16 a[126:127], v37 offset:31232
    s_mov_b32 s56, 16384
L_poll_38:
    buffer_load_dword v13, v12, s[20:23], s64 offen offset:0 sc1
    s_waitcnt vmcnt(0)
    v_cmp_ne_u32 s[58:59], s7, v13
    s_nop 0
    s_cmp_eq_u64 s[58:59], 0
    s_cbranch_scc1 L_ok_39
    s_sub_u32 s56, s56, 1
    s_cbranch_scc0 L_poll_38
L_ok_39:
    s_add_u32 m0, s49, 0x1c000
    s_lshl_b32 s40, s63, 14
    s_add_u32 s40, s40, s70
    buffer_load_dwordx4 v7, s[20:23], s40 offen sc1 lds
    buffer_load_dwordx4 v7, s[20:23], s40 offen offset:1024 sc1 lds
    s_add_u32 m0, s49, 0x1e000
    s_lshl_b32 s40, s44, 14
    s_add_u32 s40, s40, s70
    buffer_load_dwordx4 v7, s[20:23], s40 offen sc1 lds
    buffer_load_dwordx4 v7, s[20:23], s40 offen offset:1024 sc1 lds
    s_add_u32 m0, s49, 0x20000
    s_lshl_b32 s40, s45, 14
    s_add_u32 s40, s40, s70
    buffer_load_dwordx4 v7, s[20:23], s40 offen sc1 lds
    buffer_load_dwordx4 v7, s[20:23], s40 offen offset:1024 sc1 lds
    s_add_u32 m0, s49, 0x22000
    s_lshl_b32 s40, s86, 14
    s_add_u32 s40, s40, s70
    buffer_load_dwordx4 v7, s[20:23], s40 offen sc1 lds
    buffer_load_dwordx4 v7, s[20:23], s40 offen offset:1024 sc1 lds
    s_add_u32 m0, s49, 0x24000
    s_lshl_b32 s40, s87, 14
    s_add_u32 s40, s40, s70
    buffer_load_dwordx4 v7, s[20:23], s40 offen sc1 lds
    buffer_load_dwordx4 v7, s[20:23], s40 offen offset:1024 sc1 lds
    s_waitcnt vmcnt(8) lgkmcnt(0)
    s_barrier
    ds_read_b128 v[128:131], v29 offset:49152
    ds_read_b128 v[132:135], v29 offset:50176
    ds_read_b128 v[136:139], v29 offset:51200
    ds_read_b128 v[140:143], v29 offset:52224
    s_waitcnt vmcnt(4) lgkmcnt(0)
    v_mfma_f32_32x32x16_bf16 v[96:111], v[128:131], a[16:19], v[96:111]
    s_barrier
    ds_read_b128 v[144:147], v29 offset:57344
    ds_read_b128 v[148:151], v29 offset:58368
    s_add_u32 m0, s49, 0x26000
    s_lshl_b32 s40, s94, 14
    s_add_u32 s40, s40, s70
    buffer_load_dwordx4 v7, s[20:23], s40 offen sc1 lds
    v_mfma_f32_32x32x16_bf16 v[96:111], v[132:135], a[20:23], v[96:111]
    ds_read_b128 v[152:155], v29 offset:59392
    ds_read_b128 v[156:159], v29 offset:60416
    buffer_load_dwordx4 v7, s[20:23], s40 offen offset:1024 sc1 lds
    v_mfma_f32_32x32x16_bf16 v[96:111], v[136:139], a[24:27], v[96:111]
    s_add_u32 m0, s49, 0x0
    s_lshl_b32 s40, s95, 14
    s_add_u32 s40, s40, s70
    buffer_load_dwordx4 v7, s[20:23], s40 offen sc1 lds
    v_mfma_f32_32x32x16_bf16 v[96:111], v[140:143], a[28:31], v[96:111]
    buffer_load_dwordx4 v7, s[20:23], s40 offen offset:1024 sc1 lds
    s_waitcnt lgkmcnt(0)
    v_mfma_f32_32x32x16_bf16 v[96:111], v[144:147], a[32:35], v[96:111]
    ds_read_b128 v[128:131], v30 offset:0
    ds_read_b128 v[132:135], v30 offset:1024
    s_add_u32 m0, s49, 0x2000
    s_lshl_b32 s40, s63, 14
    s_add_u32 s40, s40, s71
    buffer_load_dwordx4 v7, s[20:23], s40 offen sc1 lds
    v_mfma_f32_32x32x16_bf16 v[96:111], v[148:151], a[36:39], v[96:111]
    ds_read_b128 v[136:139], v30 offset:2048
    ds_read_b128 v[140:143], v30 offset:3072
    buffer_load_dwordx4 v7, s[20:23], s40 offen offset:1024 sc1 lds
    v_mfma_f32_32x32x16_bf16 v[96:111], v[152:155], a[40:43], v[96:111]
    s_add_u32 m0, s49, 0x4000
    s_lshl_b32 s40, s44, 14
    s_add_u32 s40, s40, s71
    buffer_load_dwordx4 v7, s[20:23], s40 offen sc1 lds
    v_mfma_f32_32x32x16_bf16 v[96:111], v[156:159], a[44:47], v[96:111]
    buffer_load_dwordx4 v7, s[20:23], s40 offen offset:1024 sc1 lds
    s_waitcnt vmcnt(8) lgkmcnt(0)
    v_mfma_f32_32x32x16_bf16 v[96:111], v[128:131], a[48:51], v[96:111]
    s_barrier
    ds_read_b128 v[144:147], v30 offset:8192
    ds_read_b128 v[148:151], v30 offset:9216
    s_add_u32 m0, s49, 0x6000
    s_lshl_b32 s40, s45, 14
    s_add_u32 s40, s40, s71
    buffer_load_dwordx4 v7, s[20:23], s40 offen sc1 lds
    v_mfma_f32_32x32x16_bf16 v[96:111], v[132:135], a[52:55], v[96:111]
    ds_read_b128 v[152:155], v30 offset:10240
    ds_read_b128 v[156:159], v30 offset:11264
    buffer_load_dwordx4 v7, s[20:23], s40 offen offset:1024 sc1 lds
    v_mfma_f32_32x32x16_bf16 v[96:111], v[136:139], a[56:59], v[96:111]
    s_add_u32 m0, s49, 0x8000
    s_lshl_b32 s40, s86, 14
    s_add_u32 s40, s40, s71
    buffer_load_dwordx4 v7, s[20:23], s40 offen sc1 lds
    v_mfma_f32_32x32x16_bf16 v[96:111], v[140:143], a[60:63], v[96:111]
    buffer_load_dwordx4 v7, s[20:23], s40 offen offset:1024 sc1 lds
    s_waitcnt lgkmcnt(0)
    v_mfma_f32_32x32x16_bf16 v[96:111], v[144:147], a[64:67], v[96:111]
    ds_read_b128 v[128:131], v30 offset:16384
    ds_read_b128 v[132:135], v30 offset:17408
    s_add_u32 m0, s49, 0xa000
    s_lshl_b32 s40, s87, 14
    s_add_u32 s40, s40, s71
    buffer_load_dwordx4 v7, s[20:23], s40 offen sc1 lds
    v_mfma_f32_32x32x16_bf16 v[96:111], v[148:151], a[68:71], v[96:111]
    ds_read_b128 v[136:139], v30 offset:18432
    ds_read_b128 v[140:143], v30 offset:19456
    buffer_load_dwordx4 v7, s[20:23], s40 offen offset:1024 sc1 lds
    v_mfma_f32_32x32x16_bf16 v[96:111], v[152:155], a[72:75], v[96:111]
    s_add_u32 m0, s49, 0xc000
    s_lshl_b32 s40, s94, 14
    s_add_u32 s40, s40, s71
    buffer_load_dwordx4 v7, s[20:23], s40 offen sc1 lds
    v_mfma_f32_32x32x16_bf16 v[96:111], v[156:159], a[76:79], v[96:111]
    buffer_load_dwordx4 v7, s[20:23], s40 offen offset:1024 sc1 lds
    s_waitcnt vmcnt(10) lgkmcnt(0)
    v_mfma_f32_32x32x16_bf16 v[96:111], v[128:131], a[80:83], v[96:111]
    s_barrier
    ds_read_b128 v[144:147], v30 offset:24576
    ds_read_b128 v[148:151], v30 offset:25600
    s_add_u32 m0, s49, 0xe000
    s_lshl_b32 s40, s95, 14
    s_add_u32 s40, s40, s71
    buffer_load_dwordx4 v7, s[20:23], s40 offen sc1 lds
    v_mfma_f32_32x32x16_bf16 v[96:111], v[132:135], a[84:87], v[96:111]
    ds_read_b128 v[152:155], v30 offset:26624
    ds_read_b128 v[156:159], v30 offset:27648
    buffer_load_dwordx4 v7, s[20:23], s40 offen offset:1024 sc1 lds
    v_mfma_f32_32x32x16_bf16 v[96:111], v[136:139], a[88:91], v[96:111]
    v_mfma_f32_32x32x16_bf16 v[96:111], v[140:143], a[92:95], v[96:111]
    s_waitcnt lgkmcnt(0)
    v_mfma_f32_32x32x16_bf16 v[96:111], v[144:147], a[96:99], v[96:111]
    ds_read_b128 v[128:131], v28 offset:0
    ds_read_b128 v[132:135], v28 offset:1024
    v_mfma_f32_32x32x16_bf16 v[96:111], v[148:151], a[100:103], v[96:111]
    ds_read_b128 v[136:139], v28 offset:2048
    ds_read_b128 v[140:143], v28 offset:3072
    v_mfma_f32_32x32x16_bf16 v[96:111], v[152:155], a[104:107], v[96:111]
    v_mfma_f32_32x32x16_bf16 v[96:111], v[156:159], a[108:111], v[96:111]
    s_waitcnt lgkmcnt(0)
    v_mfma_f32_32x32x16_bf16 v[96:111], v[128:131], a[112:115], v[96:111]
    ds_read_b128 v[144:147], v28 offset:8192
    ds_read_b128 v[148:151], v28 offset:9216
    v_mfma_f32_32x32x16_bf16 v[96:111], v[132:135], a[116:119], v[96:111]
    ds_read_b128 v[152:155], v28 offset:10240
    ds_read_b128 v[156:159], v28 offset:11264
    v_mfma_f32_32x32x16_bf16 v[96:111], v[136:139], a[120:123], v[96:111]
    v_mfma_f32_32x32x16_bf16 v[96:111], v[140:143], a[124:127], v[96:111]
    s_waitcnt vmcnt(6) lgkmcnt(0)
    v_mfma_f32_32x32x16_bf16 v[112:127], v[144:147], a[16:19], v[112:127]
    s_barrier
    ds_read_b128 v[128:131], v28 offset:16384
    ds_read_b128 v[132:135], v28 offset:17408
    v_mfma_f32_32x32x16_bf16 v[112:127], v[148:151], a[20:23], v[112:127]
    ds_read_b128 v[136:139], v28 offset:18432
    ds_read_b128 v[140:143], v28 offset:19456
    v_mfma_f32_32x32x16_bf16 v[112:127], v[152:155], a[24:27], v[112:127]
    v_mfma_f32_32x32x16_bf16 v[112:127], v[156:159], a[28:31], v[112:127]
    s_waitcnt lgkmcnt(0)
    v_mfma_f32_32x32x16_bf16 v[112:127], v[128:131], a[32:35], v[112:127]
    ds_read_b128 v[144:147], v28 offset:24576
    ds_read_b128 v[148:151], v28 offset:25600
    v_mfma_f32_32x32x16_bf16 v[112:127], v[132:135], a[36:39], v[112:127]
    ds_read_b128 v[152:155], v28 offset:26624
    ds_read_b128 v[156:159], v28 offset:27648
    s_add_u32 s33, s68, 0
    buffer_store_dword v96, v2, s[24:27], s33 offen sc1
    v_mfma_f32_32x32x16_bf16 v[112:127], v[136:139], a[40:43], v[112:127]
    s_add_u32 s33, s68, 4096
    buffer_store_dword v97, v2, s[24:27], s33 offen sc1
    v_mfma_f32_32x32x16_bf16 v[112:127], v[140:143], a[44:47], v[112:127]
    s_add_u32 s33, s68, 8192
    buffer_store_dword v98, v2, s[24:27], s33 offen sc1
    s_waitcnt lgkmcnt(0)
    v_mfma_f32_32x32x16_bf16 v[112:127], v[144:147], a[48:51], v[112:127]
    ds_read_b128 v[128:131], v28 offset:32768
    ds_read_b128 v[132:135], v28 offset:33792
    v_mfma_f32_32x32x16_bf16 v[112:127], v[148:151], a[52:55], v[112:127]
    ds_read_b128 v[136:139], v28 offset:34816
    ds_read_b128 v[140:143], v28 offset:35840
    s_add_u32 s33, s68, 12288
    buffer_store_dword v99, v2, s[24:27], s33 offen sc1
    v_mfma_f32_32x32x16_bf16 v[112:127], v[152:155], a[56:59], v[112:127]
    s_add_u32 s33, s68, 32768
    buffer_store_dword v100, v2, s[24:27], s33 offen sc1
    v_mfma_f32_32x32x16_bf16 v[112:127], v[156:159], a[60:63], v[112:127]
    s_add_u32 s33, s68, 36864
    buffer_store_dword v101, v2, s[24:27], s33 offen sc1
    s_waitcnt vmcnt(6) lgkmcnt(0)
    v_mfma_f32_32x32x16_bf16 v[112:127], v[128:131], a[64:67], v[112:127]
    s_barrier
    ds_read_b128 v[144:147], v28 offset:40960
    ds_read_b128 v[148:151], v28 offset:41984
    v_mfma_f32_32x32x16_bf16 v[112:127], v[132:135], a[68:71], v[112:127]
    ds_read_b128 v[152:155], v28 offset:43008
    ds_read_b128 v[156:159], v28 offset:44032
    s_add_u32 s33, s68, 40960
    buffer_store_dword v102, v2, s[24:27], s33 offen sc1
    v_mfma_f32_32x32x16_bf16 v[112:127], v[136:139], a[72:75], v[112:127]
    s_add_u32 s33, s68, 45056
    buffer_store_dword v103, v2, s[24:27], s33 offen sc1
    v_mfma_f32_32x32x16_bf16 v[112:127], v[140:143], a[76:79], v[112:127]
    s_add_u32 s33, s68, 65536
    buffer_store_dword v104, v2, s[24:27], s33 offen sc1
    s_waitcnt lgkmcnt(0)
    s_nop 0
    v_mfma_f32_32x32x16_bf16 v[112:127], v[144:147], a[80:83], v[112:127]
    ds_read_b128 v[128:131], v28 offset:49152
    ds_read_b128 v[132:135], v28 offset:50176
    v_mfma_f32_32x32x16_bf16 v[112:127], v[148:151], a[84:87], v[112:127]
    ds_read_b128 v[136:139], v28 offset:51200
    ds_read_b128 v[140:143], v28 offset:52224
    s_add_u32 s33, s68, 69632
    buffer_store_dword v105, v2, s[24:27], s33 offen sc1
    v_mfma_f32_32x32x16_bf16 v[112:127], v[152:155], a[88:91], v[112:127]
    s_add_u32 s33, s68, 73728
    buffer_store_dword v106, v2, s[24:27], s33 offen sc1
    v_mfma_f32_32x32x16_bf16 v[112:127], v[156:159], a[92:95], v[112:127]
    s_add_u32 s33, s68, 77824
    buffer_store_dword v107, v2, s[24:27], s33 offen sc1
    s_waitcnt lgkmcnt(0)
    s_nop 0
    v_mfma_f32_32x32x16_bf16 v[112:127], v[128:131], a[96:99], v[112:127]
    ds_read_b128 v[144:147], v28 offset:57344
    ds_read_b128 v[148:151], v28 offset:58368
    v_mfma_f32_32x32x16_bf16 v[112:127], v[132:135], a[100:103], v[112:127]
    ds_read_b128 v[152:155], v28 offset:59392
    ds_read_b128 v[156:159], v28 offset:60416
    s_add_u32 s33, s68, 98304
    buffer_store_dword v108, v2, s[24:27], s33 offen sc1
    v_mfma_f32_32x32x16_bf16 v[112:127], v[136:139], a[104:107], v[112:127]
    s_add_u32 s33, s68, 102400
    buffer_store_dword v109, v2, s[24:27], s33 offen sc1
    v_mfma_f32_32x32x16_bf16 v[112:127], v[140:143], a[108:111], v[112:127]
    s_add_u32 s33, s68, 106496
    buffer_store_dword v110, v2, s[24:27], s33 offen sc1
    s_waitcnt lgkmcnt(0)
    v_mfma_f32_32x32x16_bf16 v[112:127], v[144:147], a[112:115], v[112:127]
    v_mfma_f32_32x32x16_bf16 v[112:127], v[148:151], a[116:119], v[112:127]
    s_add_u32 s33, s68, 110592
    buffer_store_dword v111, v2, s[24:27], s33 offen sc1
    v_mfma_f32_32x32x16_bf16 v[112:127], v[152:155], a[120:123], v[112:127]
    v_mfma_f32_32x32x16_bf16 v[112:127], v[156:159], a[124:127], v[112:127]
    s_add_u32 s33, s69, 0
    s_nop 10
    s_nop 0
    buffer_store_dword v112, v2, s[24:27], s33 offen sc1
    s_add_u32 s33, s69, 4096
    buffer_store_dword v113, v2, s[24:27], s33 offen sc1
    s_add_u32 s33, s69, 8192
    buffer_store_dword v114, v2, s[24:27], s33 offen sc1
    s_add_u32 s33, s69, 12288
    buffer_store_dword v115, v2, s[24:27], s33 offen sc1
    s_add_u32 s33, s69, 32768
    buffer_store_dword v116, v2, s[24:27], s33 offen sc1
    s_add_u32 s33, s69, 36864
    buffer_store_dword v117, v2, s[24:27], s33 offen sc1
    s_add_u32 s33, s69, 40960
    buffer_store_dword v118, v2, s[24:27], s33 offen sc1
    s_add_u32 s33, s69, 45056
    buffer_store_dword v119, v2, s[24:27], s33 offen sc1
    s_add_u32 s33, s69, 65536
    buffer_store_dword v120, v2, s[24:27], s33 offen sc1
    s_add_u32 s33, s69, 69632
    buffer_store_dword v121, v2, s[24:27], s33 offen sc1
    s_add_u32 s33, s69, 73728
    buffer_store_dword v122, v2, s[24:27], s33 offen sc1
    s_add_u32 s33, s69, 77824
    buffer_store_dword v123, v2, s[24:27], s33 offen sc1
    s_add_u32 s33, s69, 98304
    buffer_store_dword v124, v2, s[24:27], s33 offen sc1
    s_add_u32 s33, s69, 102400
    buffer_store_dword v125, v2, s[24:27], s33 offen sc1
    s_add_u32 s33, s69, 106496
    buffer_store_dword v126, v2, s[24:27], s33 offen sc1
    s_add_u32 s33, s69, 110592
    buffer_store_dword v127, v2, s[24:27], s33 offen sc1
    s_cmp_eq_u32 s67, 0
    s_cbranch_scc0 L_notag_40
    buffer_store_dword v11, v10, s[20:23], 0 offen offset:128 sc1
L_notag_40:
    s_endpgm
L_try1a:
    s_waitcnt vmcnt(0)
    v_xor_b32_e64 v13, v96, v8
    v_bitop3_b32 v13, v100, v8, v13 bitop3:0xbe
    v_bitop3_b32 v13, v112, v8, v13 bitop3:0xbe
    v_and_b32 v13, 0xff, v13
    v_cmp_ne_u32 s[58:59], 0, v13
    s_nop 0
    s_cmp_eq_u64 s[58:59], 0
    s_cbranch_scc1 L_try1a_ok
    buffer_load_dwordx4 v[96:99], v45, s[20:23], s74 offen sc1
    buffer_load_dwordx4 v[100:103], v45, s[20:23], s75 offen sc1
    buffer_load_dwordx4 v[112:115], v46, s[20:23], s74 offen offset:512 sc1
    s_setpc_b64 s[38:39]
L_try1a_ok:
    v_permlane16_swap_b32 v112, v114
    v_permlane16_swap_b32 v113, v115
    v_pk_add_f32 v[96:97], v[96:97], v[100:101]
    v_pk_add_f32 v[98:99], v[98:99], v[102:103]
    v_add_f32_dpp v112, v112, v112 row_ror:1 row_mask:0xf bank_mask:0xf
    v_add_f32_dpp v113, v113, v113 row_ror:1 row_mask:0xf bank_mask:0xf
    v_permlane32_swap_b32 v96, v97
    v_permlane32_swap_b32 v98, v99
    v_add_f32_dpp v112, v112, v112 row_ror:2 row_mask:0xf bank_mask:0xf
    v_add_f32_dpp v113, v113, v113 row_ror:2 row_mask:0xf bank_mask:0xf
    v_add_f32 v96, v96, v97
    v_add_f32 v98, v98, v99
    v_add_f32_dpp v112, v112, v112 row_ror:4 row_mask:0xf bank_mask:0xf
    v_add_f32_dpp v113, v113, v113 row_ror:4 row_mask:0xf bank_mask:0xf
    v_permlane16_swap_b32 v96, v98
    v_add_f32 v96, v96, v98
    v_add_f32_dpp v112, v112, v112 row_ror:8 row_mask:0xf bank_mask:0xf
    v_add_f32_dpp v113, v113, v113 row_ror:8 row_mask:0xf bank_mask:0xf
    v_add_f32_dpp v96, v96, v96 row_ror:8 row_mask:0xf bank_mask:0xf
    v_and_or_b32 v112, v112, s82, v8
    v_and_or_b32 v113, v113, s82, v8
    v_and_or_b32 v96, v96, s82, v8
    v_mov_b32 v114, v112
    v_mov_b32 v115, v113
    v_mov_b32 v97, v96
    v_permlane16_swap_b32 v112, v114
    v_permlane16_swap_b32 v113, v115
    v_permlane32_swap_b32 v96, v97
    buffer_store_dwordx4 v[112:115], v253, s[20:23], s80 offen sc1
    v_mov_b32 v98, v96
    v_mov_b32 v99, v97
    s_nop 0
    v_permlane16_swap_b32 v96, v98
    v_permlane16_swap_b32 v97, v99
    buffer_store_dwordx4 v[96:99], v41, s[20:23], s80 offen sc1
    s_mov_b32 s83, 1
    s_setpc_b64 s[38:39]
L_slow_36:
    buffer_store_dword v11, v10, s[20:23], s93 offen offset:0 sc1
    s_branch L_join_37
L_mainA:
    s_lshl_b32 s32, s28, 13
    v_bfe_u32 v9, v5, 1, 3
    v_xor_b32 v9, v9, v6
    v_lshlrev_b32 v9, 4, v9
    v_lshl_add_u32 v9, v5, 7, v9
    v_add_u32 v9, s32, v9
    v_add_u32 v9, 0x4000, v9
    v_xor_b32_e64 v24, 0, v9
    v_xor_b32 v25, 32, v9
    v_xor_b32 v26, 64, v9
    v_xor_b32 v27, 96, v9
    v_add_u32 v28, 0x10000, v24
    v_add_u32 v29, 0x10000, v25
    v_add_u32 v30, 0x10000, v26
    v_add_u32 v31, 0x10000, v27
    s_lshl_b32 s32, s29, 12
    v_bfe_u32 v9, v5, 1, 3
    v_xor_b32 v9, v9, v6
    v_lshlrev_b32 v9, 4, v9
    v_lshl_add_u32 v9, v5, 7, v9
    v_add_u32_e64 v9, s32, v9
    v_xor_b32 v32, 0, v9
    v_xor_b32 v33, 32, v9
    v_xor_b32 v34, 64, v9
    v_xor_b32 v35, 96, v9
    v_add_u32 v36, 0x10000, v32
    v_add_u32 v37, 0x10000, v33
    v_add_u32 v38, 0x10000, v34
    v_add_u32 v39, 0x10000, v35
    v_add_u32 v40, 0x20000, v32
    v_add_u32 v41, 0x20000, v33
    v_add_u32 v42, 0x20000, v34
    v_add_u32 v43, 0x20000, v35
    s_sub_u32 s57, s5, s47
    s_and_b32 s57, s57, 7
    s_and_b32 s33, s57, 3
    s_lshl_b32 s32, s33, 15
    s_lshl_b32 s46, s28, 13
    s_add_u32 s32, s32, s46
    s_add_u32 s32, s32, 0x4000
    v_bfe_u32 v9, v5, 1, 2
    v_and_b32_e64 v10, 1, v5
    v_lshl_add_u32 v9, v9, 2, v10
    v_bfe_u32 v10, v5, 4, 1
    v_lshl_add_u32 v10, v9, 1, v10
    v_bfe_u32 v11, v5, 3, 1
    v_lshl_add_u32 v10, v11, 5, v10
    v_and_b32 v9, 7, v9
    s_lshl_b32 s33, s29, 2
    v_lshl_add_u32 v11, v6, 1, s33
    v_xor_b32 v9, v9, v11
    v_lshlrev_b32 v9, 4, v9
    v_lshl_add_u32 v9, v10, 7, v9
    v_add_u32 v144, s32, v9
    v_xor_b32 v145, 16, v144
    v_xor_b32 v146, 32, v144
    v_xor_b32 v147, 48, v144
    s_mov_b32 s20, s94
    s_mov_b32 s21, s95
    s_mov_b32 s22, 0x10000000
    s_mov_b32 s23, 0x20000
    s_mov_b32 s24, s90
    s_mov_b32 s25, s91
    s_mov_b32 s26, 0x800000
    s_mov_b32 s27, 0x20000
    s_lshl_b32 s49, s3, 13
    s_mov_b32 s50, 0
    s_mov_b32 s51, -1
    s_sub_u32 s52, 0, s28
    s_mov_b32 s53, s52
    s_mov_b32 s54, 0x3fb8aa3b
    s_mov_b32 s55, 0x3fb8aa3b
    s_mov_b32 s60, 0xffff0000
    s_mov_b32 s61, 0xffff0000
    s_add_u32 s31, s4, 0
    s_lshl_b32 s66, s31, 10
    s_add_u32 s66, s66, 0x8000
    s_mov_b32 s90, 0
    s_lshl_b32 s68, s4, 19
    s_lshl_b32 s46, s28, 18
    s_add_u32 s68, s68, s46
    s_lshl_b32 s46, s5, 8
    s_add_u32 s68, s68, s46
    s_lshl_b32 s46, s29, 7
    s_add_u32 s68, s68, s46
    s_lshl_b32 s46, s90, 17
    s_add_u32 s68, s68, s46
    s_xor_b32 s69, s68, 0x20000
    s_lshl_b32 s67, s4, 8
    s_lshl_b32 s46, s5, 4
    s_add_u32 s67, s67, s46
    s_add_u32 s67, s67, s3
    s_and_b32 s32, s4, 3
    s_lshl_b32 s32, s32, 1
    s_mov_b32 s62, s5
    s_add_u32 s33, s32, 0
    s_cmp_ge_u32 s33, 7
    s_addc_u32 s33, s33, 1
    s_add_u32 s33, s33, s5
    s_and_b32 s63, s33, 7
    s_add_u32 s33, s32, 1
    s_cmp_ge_u32 s33, 7
    s_addc_u32 s33, s33, 1
    s_add_u32 s33, s33, s5
    s_and_b32 s44, s33, 7
    s_add_u32 s33, s32, 2
    s_cmp_ge_u32 s33, 7
    s_addc_u32 s33, s33, 1
    s_add_u32 s33, s33, s5
    s_and_b32 s45, s33, 7
    s_add_u32 s33, s32, 3
    s_cmp_ge_u32 s33, 7
    s_addc_u32 s33, s33, 1
    s_add_u32 s33, s33, s5
    s_and_b32 s86, s33, 7
    s_add_u32 s33, s32, 4
    s_cmp_ge_u32 s33, 7
    s_addc_u32 s33, s33, 1
    s_add_u32 s33, s33, s5
    s_and_b32 s87, s33, 7
    s_add_u32 s33, s32, 5
    s_cmp_ge_u32 s33, 7
    s_addc_u32 s33, s33, 1
    s_add_u32 s33, s33, s5
    s_and_b32 s94, s33, 7
    s_add_u32 s33, s32, 6
    s_cmp_ge_u32 s33, 7
    s_addc_u32 s33, s33, 1
    s_add_u32 s33, s33, s5
    s_and_b32 s95, s33, 7
    v_lshlrev_b32 v7, 4, v1
    v_mov_b32 v10, 0x40000000
    v_cmp_eq_u32 vcc, 0, v1
    v_lshlrev_b32 v12, 2, v5
    s_lshl_b32 s64, s31, 8
    s_add_u32 s64, s64, 0x2000
    s_lshl_b32 s93, s5, 4
    s_lshl_b32 s46, s3, 2
    s_add_u32 s93, s93, s46
    s_add_u32 s93, s93, s64
    s_getreg_b32 s91, hwreg(HW_REG_XCC_ID, 0, 4)
    v_lshlrev_b32 v15, 7, v4
    v_cndmask_b32_e64 v10, v10, 0, vcc
    v_lshlrev_b32 v2, 14, v6
    v_lshl_add_u32 v2, v5, 2, v2
    s_lshl_b32 s65, s5, 7
    s_add_u32 s65, s65, s66
    s_waitcnt lgkmcnt(0)
    s_add_u32 s7, s7, 1
    s_lshl_b32 s32, s7, 4
    s_or_b32 s91, s91, s32
    v_mov_b32 v248, s91
    v_mov_b32 v249, 0x40000000
    v_cmp_gt_u32 vcc, 32, v0
    s_nop 1
    v_cndmask_b32 v249, v249, v12, vcc
    s_lshl_b32 s72, s5, 13
    s_add_u32 s72, s72, 0x10000
    s_sub_u32 s32, 15, s4
    s_lshl_b32 s73, s32, 9
    s_lshl_b32 s46, s29, 8
    s_add_u32 s73, s73, s46
    s_add_u32 s73, s73, s72
    s_mov_b32 s76, 0xffffff00
    s_lshl_b32 s74, s4, 17
    s_lshl_b32 s46, s28, 16
    s_add_u32 s74, s74, s46
    s_lshl_b32 s46, s5, 7
    s_add_u32 s74, s74, s46
    s_lshl_b32 s46, s29, 6
    s_add_u32 s74, s74, s46
    s_lshl_b32 s46, s90, 15
    s_add_u32 s74, s74, s46
    s_xor_b32 s75, s74, 32768
    s_lshl_b32 s88, s4, 18
    s_lshl_b32 s46, s5, 15
    s_add_u32 s88, s88, s46
    s_lshl_b32 s46, s3, 12
    s_add_u32 s88, s88, s46
    s_add_u32 s88, s88, 0x400000
    s_lshl_b32 s70, s4, 18
    s_lshl_b32 s46, s3, 12
    s_add_u32 s70, s70, s46
    s_lshl_b32 s46, s90, 14
    s_add_u32 s70, s70, s46
    s_add_u32 s70, s70, 0x400000
    s_xor_b32 s71, s70, 16384
    v_lshlrev_b32 v9, 11, v6
    v_lshl_add_u32 v223, v5, 4, v9
    s_add_u32 s89, s88, 16384
    s_and_b32 s32, s7, 0xff
    v_mov_b32 v8, s32
    v_mov_b32 v11, s7
    v_lshlrev_b32 v46, 10, v5
    v_lshl_add_u32 v46, v6, 5, v46
    s_lshl_b32 s32, s29, 8
    s_add_u32 s32, s32, 0x18000
    v_lshl_add_u32 v4, v5, 3, s32
    s_lshl_b32 s32, s28, 10
    v_lshl_add_u32 v3, v6, 9, v4
    v_add_u32 v3, s32, v3
    v_lshlrev_b32 v13, 3, v5
    v_mov_b32 v14, 0x40000000
    s_or_b64 s[34:35], s[50:51], s[52:53]
    v_cndmask_b32_e64 v45, v13, v14, s[34:35]
    v_subrev_u32 v244, 1, v8
    v_subrev_u32 v245, 1, v8
    s_sub_u32 s36, 16, s4
    v_lshlrev_b32 v9, 3, v6
    v_add_u32 v9, s36, v9
    s_lshl_b32 s36, s29, 8
    v_add_u32 v13, s36, v13
    v_lshl_add_u32 v44, v9, 9, v13
    v_cmp_gt_u32 vcc, 16, v9
    s_nop 1
    v_cndmask_b32_e64 v200, 0, v8, vcc
    v_cmp_gt_u32 vcc, 15, v9
    s_nop 1
    v_cndmask_b32_e64 v201, 0, v8, vcc
    v_cmp_gt_u32 vcc, 14, v9
    s_nop 1
    v_cndmask_b32_e64 v202, 0, v8, vcc
    v_cmp_gt_u32 vcc, 13, v9
    s_nop 1
    v_cndmask_b32_e64 v203, 0, v8, vcc
    v_cmp_gt_u32 vcc, 12, v9
    s_nop 1
    v_cndmask_b32_e64 v204, 0, v8, vcc
    v_cmp_gt_u32 vcc, 11, v9
    s_nop 1
    v_cndmask_b32_e64 v205, 0, v8, vcc
    v_cmp_gt_u32 vcc, 10, v9
    s_nop 1
    v_cndmask_b32_e64 v206, 0, v8, vcc
    v_cmp_gt_u32 vcc, 9, v9
    s_nop 1
    v_cndmask_b32_e64 v207, 0, v8, vcc
    s_waitcnt vmcnt(8)
    v_and_b32 v9, 1, v5
    v_lshlrev_b32 v9, 4, v9
    v_lshlrev_b32 v222, v9, v222
    v_lshrrev_b32 v9, 1, v5
    v_lshlrev_b32 v13, 3, v6
    v_sub_u32 v9, v9, v13
    v_cmp_eq_u32 vcc, 0, v9
    s_nop 1
    v_cndmask_b32_e64 v192, 0, v222, vcc
    v_cmp_eq_u32 vcc, 1, v9
    s_nop 1
    v_cndmask_b32_e64 v193, 0, v222, vcc
    v_cmp_eq_u32 vcc, 2, v9
    s_nop 1
    v_cndmask_b32_e64 v194, 0, v222, vcc
    v_cmp_eq_u32 vcc, 3, v9
    s_nop 1
    v_cndmask_b32_e64 v195, 0, v222, vcc
    v_cmp_eq_u32 vcc, 4, v9
    s_nop 1
    v_cndmask_b32_e64 v196, 0, v222, vcc
    v_cmp_eq_u32 vcc, 5, v9
    s_nop 1
    v_cndmask_b32_e64 v197, 0, v222, vcc
    v_cmp_eq_u32 vcc, 6, v9
    s_nop 1
    v_cndmask_b32_e64 v198, 0, v222, vcc
    v_cmp_eq_u32 vcc, 7, v9
    s_nop 1
    v_cndmask_b32_e64 v199, 0, v222, vcc
    v_lshlrev_b32 v224, 16, v224
    v_lshlrev_b32 v225, 16, v225
    v_lshlrev_b32 v226, 16, v226
    v_mul_f32 v226, s54, v226
    v_exp_f32 v226, v226
    s_nop 0
    v_cvt_pk_bf16_f32 v226, v226, v226
    v_lshlrev_b32 v226, 16, v226
    v_mul_f32 v228, v226, v224
    v_mul_f32 v229, v226, v225
    v_mul_f32 v228, s54, v228
    v_exp_f32 v228, v228
    v_mul_f32 v229, 0x3e22f983, v229
    v_rndne_f32 v230, v229
    v_sub_f32 v229, v229, v230
    v_cos_f32 v230, v229
    v_sin_f32 v231, v229
    v_mul_f32 v208, v228, v230
    v_mul_f32 v209, v228, v231
    v_add_f32 v228, -1.0, v208
    v_mul_f32 v229, v224, v224
    v_fmac_f32 v229, v225, v225
    v_rcp_f32 v229, v229
    v_mul_f32 v230, v228, v224
    v_fmac_f32 v230, v209, v225
    v_mul_f32 v231, v209, v224
    v_fma_f32 v231, -v228, v225, v231
    v_add_f32_e64 v229, v229, v229
    v_mul_f32 v220, v230, v229
    v_mul_f32 v221, v231, v229
    v_pk_mul_f32 v[236:237], v[208:209], v[208:209] op_sel:[1,1] op_sel_hi:[1,0] neg_lo:[1,0]
    v_pk_fma_f32 v[232:233], v[208:209], v[208:209], v[236:237] op_sel:[0,0,0] op_sel_hi:[0,1,1]
    v_pk_mul_f32 v[236:237], v[232:233], v[232:233] op_sel:[1,1] op_sel_hi:[1,0] neg_lo:[1,0]
    v_pk_fma_f32 v[234:235], v[232:233], v[232:233], v[236:237] op_sel:[0,0,0] op_sel_hi:[0,1,1]
    v_pk_mul_f32 v[236:237], v[234:235], v[234:235] op_sel:[1,1] op_sel_hi:[1,0] neg_lo:[1,0]
    v_pk_fma_f32 v[232:233], v[234:235], v[234:235], v[236:237] op_sel:[0,0,0] op_sel_hi:[0,1,1]
    v_pk_mul_f32 v[236:237], v[232:233], v[232:233] op_sel:[1,1] op_sel_hi:[1,0] neg_lo:[1,0]
    v_pk_fma_f32 v[210:211], v[232:233], v[232:233], v[236:237] op_sel:[0,0,0] op_sel_hi:[0,1,1]
    v_pk_mul_f32 v[236:237], v[210:211], v[210:211] op_sel:[1,1] op_sel_hi:[1,0] neg_lo:[1,0]
    v_pk_fma_f32 v[212:213], v[210:211], v[210:211], v[236:237] op_sel:[0,0,0] op_sel_hi:[0,1,1]
    v_pk_mul_f32 v[236:237], v[212:213], v[212:213] op_sel:[1,1] op_sel_hi:[1,0] neg_lo:[1,0]
    v_pk_fma_f32 v[232:233], v[212:213], v[212:213], v[236:237] op_sel:[0,0,0] op_sel_hi:[0,1,1]
    v_pk_mul_f32 v[236:237], v[232:233], v[232:233] op_sel:[1,1] op_sel_hi:[1,0] neg_lo:[1,0]
    v_pk_fma_f32 v[214:215], v[232:233], v[232:233], v[236:237] op_sel:[0,0,0] op_sel_hi:[0,1,1]
    v_cndmask_b32_e64 v238, 1.0, v212, s[50:51]
    v_cndmask_b32_e64 v239, 0, v213, s[50:51]
    v_cndmask_b32_e64 v240, 1.0, v232, s[52:53]
    v_cndmask_b32_e64 v241, 0, v233, s[52:53]
    v_pk_mul_f32 v[236:237], v[238:239], v[240:241] op_sel:[1,1] op_sel_hi:[1,0] neg_lo:[1,0]
    v_pk_fma_f32 v[216:217], v[238:239], v[240:241], v[236:237] op_sel:[0,0,0] op_sel_hi:[0,1,1]
    v_pk_mul_f32 v[236:237], v[214:215], v[214:215] op_sel:[1,1] op_sel_hi:[1,0] neg_lo:[1,0]
    v_pk_fma_f32 v[232:233], v[214:215], v[214:215], v[236:237] op_sel:[0,0,0] op_sel_hi:[0,1,1]
    v_pk_mul_f32 v[236:237], v[232:233], v[232:233] op_sel:[1,1] op_sel_hi:[1,0] neg_lo:[1,0]
    v_pk_fma_f32 v[234:235], v[232:233], v[232:233], v[236:237] op_sel:[0,0,0] op_sel_hi:[0,1,1]
    v_pk_mul_f32 v[236:237], v[234:235], v[234:235] op_sel:[1,1] op_sel_hi:[1,0] neg_lo:[1,0]
    v_pk_fma_f32 v[232:233], v[234:235], v[234:235], v[236:237] op_sel:[0,0,0] op_sel_hi:[0,1,1]
    v_cndmask_b32_e64 v218, 1.0, v232, s[50:51]
    v_cndmask_b32_e64 v219, 0, v233, s[50:51]
    s_add_u32 m0, s48, 0x8000
    s_add_u32 s40, s47, 1
    s_and_b32 s40, s40, 7
    s_lshl_b32 s40, s40, 7
    buffer_load_dwordx4 v20, s[12:15], s40 offen offset:0 lds
    buffer_load_dwordx4 v21, s[12:15], s40 offen offset:1024 lds
    buffer_load_dwordx4 v22, s[12:15], s40 offen offset:2048 lds
    buffer_load_dwordx4 v23, s[12:15], s40 offen offset:3072 lds
    s_add_u32 m0, s48, 0xc000
    s_nop 0
    buffer_load_dwordx4 v16, s[8:11], s40 offen offset:0 lds
    buffer_load_dwordx4 v17, s[8:11], s40 offen offset:1024 lds
    buffer_load_dwordx4 v18, s[8:11], s40 offen offset:2048 lds
    buffer_load_dwordx4 v19, s[8:11], s40 offen offset:3072 lds
    s_add_u32 m0, s48, 0x10000
    s_add_u32 s40, s47, 2
    s_and_b32 s40, s40, 7
    s_lshl_b32 s40, s40, 7
    buffer_load_dwordx4 v20, s[12:15], s40 offen offset:0 lds
    buffer_load_dwordx4 v21, s[12:15], s40 offen offset:1024 lds
    buffer_load_dwordx4 v22, s[12:15], s40 offen offset:2048 lds
    buffer_load_dwordx4 v23, s[12:15], s40 offen offset:3072 lds
    s_add_u32 m0, s48, 0x14000
    s_nop 0
    buffer_load_dwordx4 v16, s[8:11], s40 offen offset:0 lds
    buffer_load_dwordx4 v17, s[8:11], s40 offen offset:1024 lds
    buffer_load_dwordx4 v18, s[8:11], s40 offen offset:2048 lds
    buffer_load_dwordx4 v19, s[8:11], s40 offen offset:3072 lds
    s_waitcnt vmcnt(16)
    s_barrier
    ds_read_b128 v[48:51], v24 offset:0
    ds_read_b128 v[64:67], v32 offset:0
    ds_read_b128 v[68:71], v32 offset:8192
    ds_read_b128 v[52:55], v24 offset:4096
    s_waitcnt lgkmcnt(0)
    v_mfma_f32_32x32x16_bf16 v[80:95], v[48:51], v[64:67], 0
    ds_read_b128 v[56:59], v25 offset:0
    ds_read_b128 v[72:75], v33 offset:0
    v_mfma_f32_32x32x16_bf16 v[112:127], v[48:51], v[68:71], 0
    ds_read_b128 v[76:79], v33 offset:8192
    ds_read_b128 v[60:63], v25 offset:4096
    v_mfma_f32_32x32x16_bf16 v[128:143], v[52:55], v[68:71], 0
    s_add_u32 m0, s48, 0x18000
    s_add_u32 s40, s47, 3
    s_and_b32 s40, s40, 7
    s_lshl_b32 s40, s40, 7
    buffer_load_dwordx4 v20, s[12:15], s40 offen offset:0 lds
    v_mfma_f32_32x32x16_bf16 v[96:111], v[52:55], v[64:67], 0
    buffer_load_dwordx4 v21, s[12:15], s40 offen offset:1024 lds
    s_waitcnt lgkmcnt(0)
    v_mfma_f32_32x32x16_bf16 v[80:95], v[56:59], v[72:75], v[80:95]
    ds_read_b128 v[48:51], v26 offset:0
    ds_read_b128 v[64:67], v34 offset:0
    v_mfma_f32_32x32x16_bf16 v[112:127], v[56:59], v[76:79], v[112:127]
    ds_read_b128 v[68:71], v34 offset:8192
    ds_read_b128 v[52:55], v26 offset:4096
    s_cmp_eq_u32 s57, 0
    s_cbranch_scc0 L_nx_1
    ds_read_b128 v[176:179], v144 offset:0
    ds_read_b128 v[180:183], v145 offset:0
    ds_read_b128 v[184:187], v146 offset:512
    ds_read_b128 v[188:191], v147 offset:512
L_nx_1:
    v_mfma_f32_32x32x16_bf16 v[128:143], v[60:63], v[76:79], v[128:143]
    buffer_load_dwordx4 v22, s[12:15], s40 offen offset:2048 lds
    v_mfma_f32_32x32x16_bf16 v[96:111], v[60:63], v[72:75], v[96:111]
    buffer_load_dwordx4 v23, s[12:15], s40 offen offset:3072 lds
    s_waitcnt lgkmcnt(0)
    v_mfma_f32_32x32x16_bf16 v[80:95], v[48:51], v[64:67], v[80:95]
    ds_read_b128 v[56:59], v27 offset:0
    ds_read_b128 v[72:75], v35 offset:0
    v_mfma_f32_32x32x16_bf16 v[112:127], v[48:51], v[68:71], v[112:127]
    ds_read_b128 v[76:79], v35 offset:8192
    ds_read_b128 v[60:63], v27 offset:4096
    v_mfma_f32_32x32x16_bf16 v[128:143], v[52:55], v[68:71], v[128:143]
    s_add_u32 m0, s48, 0x1c000
    s_nop 0
    buffer_load_dwordx4 v16, s[8:11], s40 offen offset:0 lds
    v_mfma_f32_32x32x16_bf16 v[96:111], v[52:55], v[64:67], v[96:111]
    buffer_load_dwordx4 v17, s[8:11], s40 offen offset:1024 lds
    s_waitcnt vmcnt(14) lgkmcnt(0)
    v_mfma_f32_32x32x16_bf16 v[80:95], v[56:59], v[72:75], v[80:95]
    s_barrier
    ds_read_b128 v[48:51], v24 offset:32768
    ds_read_b128 v[64:67], v32 offset:32768
    v_mfma_f32_32x32x16_bf16 v[112:127], v[56:59], v[76:79], v[112:127]
    ds_read_b128 v[68:71], v32 offset:40960
    ds_read_b128 v[52:55], v24 offset:36864
    v_mfma_f32_32x32x16_bf16 v[128:143], v[60:63], v[76:79], v[128:143]
    buffer_load_dwordx4 v18, s[8:11], s40 offen offset:2048 lds
    v_mfma_f32_32x32x16_bf16 v[96:111], v[60:63], v[72:75], v[96:111]
    buffer_load_dwordx4 v19, s[8:11], s40 offen offset:3072 lds
    s_waitcnt lgkmcnt(0)
    v_mfma_f32_32x32x16_bf16 v[80:95], v[48:51], v[64:67], v[80:95]
    ds_read_b128 v[56:59], v25 offset:32768
    ds_read_b128 v[72:75], v33 offset:32768
    v_mfma_f32_32x32x16_bf16 v[112:127], v[48:51], v[68:71], v[112:127]
    ds_read_b128 v[76:79], v33 offset:40960
    ds_read_b128 v[60:63], v25 offset:36864
    v_mfma_f32_32x32x16_bf16 v[128:143], v[52:55], v[68:71], v[128:143]
    s_add_u32 m0, s48, 0x0
    s_add_u32 s40, s47, 4
    s_and_b32 s40, s40, 7
    s_lshl_b32 s40, s40, 7
    buffer_load_dwordx4 v20, s[12:15], s40 offen offset:0 lds
    v_mfma_f32_32x32x16_bf16 v[96:111], v[52:55], v[64:67], v[96:111]
    buffer_load_dwordx4 v21, s[12:15], s40 offen offset:1024 lds
    s_waitcnt lgkmcnt(0)
    v_mfma_f32_32x32x16_bf16 v[80:95], v[56:59], v[72:75], v[80:95]
    ds_read_b128 v[48:51], v26 offset:32768
    ds_read_b128 v[64:67], v34 offset:32768
    v_mfma_f32_32x32x16_bf16 v[112:127], v[56:59], v[76:79], v[112:127]
    ds_read_b128 v[68:71], v34 offset:40960
    ds_read_b128 v[52:55], v26 offset:36864
    s_cmp_eq_u32 s57, 1
    s_cbranch_scc0 L_nx_2
    ds_read_b128 v[176:179], v144 offset:0
    ds_read_b128 v[180:183], v145 offset:0
    ds_read_b128 v[184:187], v146 offset:512
    ds_read_b128 v[188:191], v147 offset:512
L_nx_2:
    v_mfma_f32_32x32x16_bf16 v[128:143], v[60:63], v[76:79], v[128:143]
    buffer_load_dwordx4 v22, s[12:15], s40 offen offset:2048 lds
    v_mfma_f32_32x32x16_bf16 v[96:111], v[60:63], v[72:75], v[96:111]
    buffer_load_dwordx4 v23, s[12:15], s40 offen offset:3072 lds
    s_waitcnt lgkmcnt(0)
    v_mfma_f32_32x32x16_bf16 v[80:95], v[48:51], v[64:67], v[80:95]
    ds_read_b128 v[56:59], v27 offset:32768
    ds_read_b128 v[72:75], v35 offset:32768
    v_mfma_f32_32x32x16_bf16 v[112:127], v[48:51], v[68:71], v[112:127]
    ds_read_b128 v[76:79], v35 offset:40960
    ds_read_b128 v[60:63], v27 offset:36864
    v_mfma_f32_32x32x16_bf16 v[128:143], v[52:55], v[68:71], v[128:143]
    s_add_u32 m0, s48, 0x4000
    s_nop 0
    buffer_load_dwordx4 v16, s[8:11], s40 offen offset:0 lds
    v_mfma_f32_32x32x16_bf16 v[96:111], v[52:55], v[64:67], v[96:111]
    buffer_load_dwordx4 v17, s[8:11], s40 offen offset:1024 lds
    s_waitcnt vmcnt(14) lgkmcnt(0)
    v_mfma_f32_32x32x16_bf16 v[80:95], v[56:59], v[72:75], v[80:95]
    s_barrier
    ds_read_b128 v[48:51], v28 offset:0
    ds_read_b128 v[64:67], v36 offset:0
    v_mfma_f32_32x32x16_bf16 v[112:127], v[56:59], v[76:79], v[112:127]
    ds_read_b128 v[68:71], v36 offset:8192
    ds_read_b128 v[52:55], v28 offset:4096
    v_mfma_f32_32x32x16_bf16 v[128:143], v[60:63], v[76:79], v[128:143]
    buffer_load_dwordx4 v18, s[8:11], s40 offen offset:2048 lds
    v_mfma_f32_32x32x16_bf16 v[96:111], v[60:63], v[72:75], v[96:111]
    buffer_load_dwordx4 v19, s[8:11], s40 offen offset:3072 lds
    s_waitcnt lgkmcnt(0)
    v_mfma_f32_32x32x16_bf16 v[80:95], v[48:51], v[64:67], v[80:95]
    ds_read_b128 v[56:59], v29 offset:0
    ds_read_b128 v[72:75], v37 offset:0
    v_mfma_f32_32x32x16_bf16 v[112:127], v[48:51], v[68:71], v[112:127]
    ds_read_b128 v[76:79], v37 offset:8192
    ds_read_b128 v[60:63], v29 offset:4096
    v_mfma_f32_32x32x16_bf16 v[128:143], v[52:55], v[68:71], v[128:143]
    s_add_u32 m0, s48, 0x8000
    s_add_u32 s40, s47, 5
    s_and_b32 s40, s40, 7
    s_lshl_b32 s40, s40, 7
    buffer_load_dwordx4 v20, s[12:15], s40 offen offset:0 lds
    v_mfma_f32_32x32x16_bf16 v[96:111], v[52:55], v[64:67], v[96:111]
    buffer_load_dwordx4 v21, s[12:15], s40 offen offset:1024 lds
    s_waitcnt lgkmcnt(0)
    v_mfma_f32_32x32x16_bf16 v[80:95], v[56:59], v[72:75], v[80:95]
    ds_read_b128 v[48:51], v30 offset:0
    ds_read_b128 v[64:67], v38 offset:0
    v_mfma_f32_32x32x16_bf16 v[112:127], v[56:59], v[76:79], v[112:127]
    ds_read_b128 v[68:71], v38 offset:8192
    ds_read_b128 v[52:55], v30 offset:4096
    s_cmp_eq_u32 s57, 2
    s_cbranch_scc0 L_nx_3
    ds_read_b128 v[176:179], v144 offset:0
    ds_read_b128 v[180:183], v145 offset:0
    ds_read_b128 v[184:187], v146 offset:512
    ds_read_b128 v[188:191], v147 offset:512
L_nx_3:
    v_mfma_f32_32x32x16_bf16 v[128:143], v[60:63], v[76:79], v[128:143]
    buffer_load_dwordx4 v22, s[12:15], s40 offen offset:2048 lds
    v_mfma_f32_32x32x16_bf16 v[96:111], v[60:63], v[72:75], v[96:111]
    buffer_load_dwordx4 v23, s[12:15], s40 offen offset:3072 lds
    s_waitcnt lgkmcnt(0)
    v_mfma_f32_32x32x16_bf16 v[80:95], v[48:51], v[64:67], v[80:95]
    ds_read_b128 v[56:59], v31 offset:0
    ds_read_b128 v[72:75], v39 offset:0
    v_mfma_f32_32x32x16_bf16 v[112:127], v[48:51], v[68:71], v[112:127]
    ds_read_b128 v[76:79], v39 offset:8192
    ds_read_b128 v[60:63], v31 offset:4096
    v_mfma_f32_32x32x16_bf16 v[128:143], v[52:55], v[68:71], v[128:143]
    s_add_u32 m0, s48, 0xc000
    s_nop 0
    buffer_load_dwordx4 v16, s[8:11], s40 offen offset:0 lds
    v_mfma_f32_32x32x16_bf16 v[96:111], v[52:55], v[64:67], v[96:111]
    buffer_load_dwordx4 v17, s[8:11], s40 offen offset:1024 lds
    s_waitcnt vmcnt(14) lgkmcnt(0)
    v_mfma_f32_32x32x16_bf16 v[80:95], v[56:59], v[72:75], v[80:95]
    s_barrier
    ds_read_b128 v[48:51], v28 offset:32768
    ds_read_b128 v[64:67], v36 offset:32768
    v_mfma_f32_32x32x16_bf16 v[112:127], v[56:59], v[76:79], v[112:127]
    ds_read_b128 v[68:71], v36 offset:40960
    ds_read_b128 v[52:55], v28 offset:36864
    v_mfma_f32_32x32x16_bf16 v[128:143], v[60:63], v[76:79], v[128:143]
    buffer_load_dwordx4 v18, s[8:11], s40 offen offset:2048 lds
    v_mfma_f32_32x32x16_bf16 v[96:111], v[60:63], v[72:75], v[96:111]
    buffer_load_dwordx4 v19, s[8:11], s40 offen offset:3072 lds
    s_waitcnt lgkmcnt(0)
    v_mfma_f32_32x32x16_bf16 v[80:95], v[48:51], v[64:67], v[80:95]
    ds_read_b128 v[56:59], v29 offset:32768
    ds_read_b128 v[72:75], v37 offset:32768
    v_mfma_f32_32x32x16_bf16 v[112:127], v[48:51], v[68:71], v[112:127]
    ds_read_b128 v[76:79], v37 offset:40960
    ds_read_b128 v[60:63], v29 offset:36864
    v_mfma_f32_32x32x16_bf16 v[128:143], v[52:55], v[68:71], v[128:143]
    s_add_u32 m0, s48, 0x10000
    s_add_u32 s40, s47, 6
    s_and_b32 s40, s40, 7
    s_lshl_b32 s40, s40, 7
    buffer_load_dwordx4 v20, s[12:15], s40 offen offset:0 lds
    v_mfma_f32_32x32x16_bf16 v[96:111], v[52:55], v[64:67], v[96:111]
    buffer_load_dwordx4 v21, s[12:15], s40 offen offset:1024 lds
    s_waitcnt lgkmcnt(0)
    v_mfma_f32_32x32x16_bf16 v[80:95], v[56:59], v[72:75], v[80:95]
    ds_read_b128 v[48:51], v30 offset:32768
    ds_read_b128 v[64:67], v38 offset:32768
    v_mfma_f32_32x32x16_bf16 v[112:127], v[56:59], v[76:79], v[112:127]
    ds_read_b128 v[68:71], v38 offset:40960
    ds_read_b128 v[52:55], v30 offset:36864
    s_cmp_eq_u32 s57, 3
    s_cbranch_scc0 L_nx_4
    ds_read_b128 v[176:179], v144 offset:0
    ds_read_b128 v[180:183], v145 offset:0
    ds_read_b128 v[184:187], v146 offset:512
    ds_read_b128 v[188:191], v147 offset:512
L_nx_4:
    v_mfma_f32_32x32x16_bf16 v[128:143], v[60:63], v[76:79], v[128:143]
    buffer_load_dwordx4 v22, s[12:15], s40 offen offset:2048 lds
    v_mfma_f32_32x32x16_bf16 v[96:111], v[60:63], v[72:75], v[96:111]
    buffer_load_dwordx4 v23, s[12:15], s40 offen offset:3072 lds
    s_waitcnt lgkmcnt(0)
    v_mfma_f32_32x32x16_bf16 v[80:95], v[48:51], v[64:67], v[80:95]
    ds_read_b128 v[56:59], v31 offset:32768
    ds_read_b128 v[72:75], v39 offset:32768
    v_mfma_f32_32x32x16_bf16 v[112:127], v[48:51], v[68:71], v[112:127]
    ds_read_b128 v[76:79], v39 offset:40960
    ds_read_b128 v[60:63], v31 offset:36864
    v_mfma_f32_32x32x16_bf16 v[128:143], v[52:55], v[68:71], v[128:143]
    s_add_u32 m0, s48, 0x14000
    s_nop 0
    buffer_load_dwordx4 v16, s[8:11], s40 offen offset:0 lds
    v_mfma_f32_32x32x16_bf16 v[96:111], v[52:55], v[64:67], v[96:111]
    buffer_load_dwordx4 v17, s[8:11], s40 offen offset:1024 lds
    s_waitcnt vmcnt(14) lgkmcnt(0)
    v_mfma_f32_32x32x16_bf16 v[80:95], v[56:59], v[72:75], v[80:95]
    s_barrier
    ds_read_b128 v[48:51], v24 offset:0
    ds_read_b128 v[64:67], v32 offset:0
    v_mfma_f32_32x32x16_bf16 v[112:127], v[56:59], v[76:79], v[112:127]
    ds_read_b128 v[68:71], v32 offset:8192
    ds_read_b128 v[52:55], v24 offset:4096
    v_mfma_f32_32x32x16_bf16 v[128:143], v[60:63], v[76:79], v[128:143]
    buffer_load_dwordx4 v18, s[8:11], s40 offen offset:2048 lds
    v_mfma_f32_32x32x16_bf16 v[96:111], v[60:63], v[72:75], v[96:111]
    buffer_load_dwordx4 v19, s[8:11], s40 offen offset:3072 lds
    s_waitcnt lgkmcnt(0)
    v_mfma_f32_32x32x16_bf16 v[80:95], v[48:51], v[64:67], v[80:95]
    ds_read_b128 v[56:59], v25 offset:0
    ds_read_b128 v[72:75], v33 offset:0
    v_mfma_f32_32x32x16_bf16 v[112:127], v[48:51], v[68:71], v[112:127]
    ds_read_b128 v[76:79], v33 offset:8192
    ds_read_b128 v[60:63], v25 offset:4096
    v_mfma_f32_32x32x16_bf16 v[128:143], v[52:55], v[68:71], v[128:143]
    s_add_u32 m0, s48, 0x18000
    s_add_u32 s40, s47, 7
    s_and_b32 s40, s40, 7
    s_lshl_b32 s40, s40, 7
    buffer_load_dwordx4 v20, s[12:15], s40 offen offset:0 lds
    v_mfma_f32_32x32x16_bf16 v[96:111], v[52:55], v[64:67], v[96:111]
    buffer_load_dwordx4 v21, s[12:15], s40 offen offset:1024 lds
    s_waitcnt lgkmcnt(0)
    v_mfma_f32_32x32x16_bf16 v[80:95], v[56:59], v[72:75], v[80:95]
    ds_read_b128 v[48:51], v26 offset:0
    ds_read_b128 v[64:67], v34 offset:0
    v_mfma_f32_32x32x16_bf16 v[112:127], v[56:59], v[76:79], v[112:127]
    ds_read_b128 v[68:71], v34 offset:8192
    ds_read_b128 v[52:55], v26 offset:4096
    s_cmp_eq_u32 s57, 4
    s_cbranch_scc0 L_nx_5
    ds_read_b128 v[176:179], v144 offset:0
    ds_read_b128 v[180:183], v145 offset:0
    ds_read_b128 v[184:187], v146 offset:512
    ds_read_b128 v[188:191], v147 offset:512
L_nx_5:
    v_mfma_f32_32x32x16_bf16 v[128:143], v[60:63], v[76:79], v[128:143]
    buffer_load_dwordx4 v22, s[12:15], s40 offen offset:2048 lds
    v_mfma_f32_32x32x16_bf16 v[96:111], v[60:63], v[72:75], v[96:111]
    buffer_load_dwordx4 v23, s[12:15], s40 offen offset:3072 lds
    s_waitcnt lgkmcnt(0)
    v_mfma_f32_32x32x16_bf16 v[80:95], v[48:51], v[64:67], v[80:95]
    ds_read_b128 v[56:59], v27 offset:0
    ds_read_b128 v[72:75], v35 offset:0
    v_mfma_f32_32x32x16_bf16 v[112:127], v[48:51], v[68:71], v[112:127]
    ds_read_b128 v[76:79], v35 offset:8192
    ds_read_b128 v[60:63], v27 offset:4096
    v_mfma_f32_32x32x16_bf16 v[128:143], v[52:55], v[68:71], v[128:143]
    s_add_u32 m0, s48, 0x1c000
    s_nop 0
    buffer_load_dwordx4 v16, s[8:11], s40 offen offset:0 lds
    v_mfma_f32_32x32x16_bf16 v[96:111], v[52:55], v[64:67], v[96:111]
    buffer_load_dwordx4 v17, s[8:11], s40 offen offset:1024 lds
    s_waitcnt vmcnt(14) lgkmcnt(0)
    v_mfma_f32_32x32x16_bf16 v[80:95], v[56:59], v[72:75], v[80:95]
    s_barrier
    ds_read_b128 v[48:51], v24 offset:32768
    ds_read_b128 v[64:67], v32 offset:32768
    v_mfma_f32_32x32x16_bf16 v[112:127], v[56:59], v[76:79], v[112:127]
    ds_read_b128 v[68:71], v32 offset:40960
    ds_read_b128 v[52:55], v24 offset:36864
    v_mfma_f32_32x32x16_bf16 v[128:143], v[60:63], v[76:79], v[128:143]
    buffer_load_dwordx4 v18, s[8:11], s40 offen offset:2048 lds
    v_mfma_f32_32x32x16_bf16 v[96:111], v[60:63], v[72:75], v[96:111]
    buffer_load_dwordx4 v19, s[8:11], s40 offen offset:3072 lds
    s_waitcnt lgkmcnt(0)
    v_mfma_f32_32x32x16_bf16 v[80:95], v[48:51], v[64:67], v[80:95]
    ds_read_b128 v[56:59], v25 offset:32768
    ds_read_b128 v[72:75], v33 offset:32768
    v_mfma_f32_32x32x16_bf16 v[112:127], v[48:51], v[68:71], v[112:127]
    ds_read_b128 v[76:79], v33 offset:40960
    ds_read_b128 v[60:63], v25 offset:36864
    v_mfma_f32_32x32x16_bf16 v[128:143], v[52:55], v[68:71], v[128:143]
    buffer_store_dword v248, v249, s[20:23], s65 offen sc1
    v_mfma_f32_32x32x16_bf16 v[96:111], v[52:55], v[64:67], v[96:111]
    buffer_store_dwordx2 v[244:245], v45, s[20:23], s73 offen sc1
    s_waitcnt lgkmcnt(0)
    v_mfma_f32_32x32x16_bf16 v[80:95], v[56:59], v[72:75], v[80:95]
    ds_read_b128 v[48:51], v26 offset:32768
    ds_read_b128 v[64:67], v34 offset:32768
    v_mfma_f32_32x32x16_bf16 v[112:127], v[56:59], v[76:79], v[112:127]
    ds_read_b128 v[68:71], v34 offset:40960
    ds_read_b128 v[52:55], v26 offset:36864
    s_cmp_eq_u32 s57, 5
    s_cbranch_scc0 L_nx_6
    ds_read_b128 v[176:179], v144 offset:0
    ds_read_b128 v[180:183], v145 offset:0
    ds_read_b128 v[184:187], v146 offset:512
    ds_read_b128 v[188:191], v147 offset:512
L_nx_6:
    v_mfma_f32_32x32x16_bf16 v[128:143], v[60:63], v[76:79], v[128:143]
    s_add_u32 m0, s48, 0x20000
    s_lshl_b32 s41, s63, 7
    buffer_load_dwordx4 v20, s[16:19], s41 offen offset:0 lds
    v_mfma_f32_32x32x16_bf16 v[96:111], v[60:63], v[72:75], v[96:111]
    buffer_load_dwordx4 v21, s[16:19], s41 offen offset:1024 lds
    s_waitcnt lgkmcnt(0)
    v_mfma_f32_32x32x16_bf16 v[80:95], v[48:51], v[64:67], v[80:95]
    ds_read_b128 v[56:59], v27 offset:32768
    ds_read_b128 v[72:75], v35 offset:32768
    v_mfma_f32_32x32x16_bf16 v[112:127], v[48:51], v[68:71], v[112:127]
    ds_read_b128 v[76:79], v35 offset:40960
    ds_read_b128 v[60:63], v27 offset:36864
    v_mfma_f32_32x32x16_bf16 v[128:143], v[52:55], v[68:71], v[128:143]
    buffer_load_dwordx4 v22, s[16:19], s41 offen offset:2048 lds
    v_mfma_f32_32x32x16_bf16 v[96:111], v[52:55], v[64:67], v[96:111]
    buffer_load_dwordx4 v23, s[16:19], s41 offen offset:3072 lds
    s_waitcnt vmcnt(14) lgkmcnt(0)
    v_mfma_f32_32x32x16_bf16 v[80:95], v[56:59], v[72:75], v[80:95]
    s_barrier
    ds_read_b128 v[48:51], v28 offset:0
    ds_read_b128 v[64:67], v36 offset:0
    v_mfma_f32_32x32x16_bf16 v[112:127], v[56:59], v[76:79], v[112:127]
    ds_read_b128 v[68:71], v36 offset:8192
    ds_read_b128 v[52:55], v28 offset:4096
    v_mfma_f32_32x32x16_bf16 v[128:143], v[60:63], v[76:79], v[128:143]
    s_add_u32 m0, s48, 0x0
    s_and_b32 s41, s4, 3
    s_cmp_eq_u32 s41, 3
    s_cselect_b32 s41, 0x0, 0x24000
    s_cselect_b32 s39, s62, s44
    s_add_u32 m0, s48, s41
    s_lshl_b32 s41, s39, 7
    buffer_load_dwordx4 v20, s[16:19], s41 offen offset:0 lds
    v_mfma_f32_32x32x16_bf16 v[96:111], v[60:63], v[72:75], v[96:111]
    buffer_load_dwordx4 v21, s[16:19], s41 offen offset:1024 lds
    s_waitcnt lgkmcnt(0)
    v_mfma_f32_32x32x16_bf16 v[80:95], v[48:51], v[64:67], v[80:95]
    ds_read_b128 v[56:59], v29 offset:0
    ds_read_b128 v[72:75], v37 offset:0
    v_mfma_f32_32x32x16_bf16 v[112:127], v[48:51], v[68:71], v[112:127]
    ds_read_b128 v[76:79], v37 offset:8192
    ds_read_b128 v[60:63], v29 offset:4096
    v_mfma_f32_32x32x16_bf16 v[128:143], v[52:55], v[68:71], v[128:143]
    buffer_load_dwordx4 v22, s[16:19], s41 offen offset:2048 lds
    v_mfma_f32_32x32x16_bf16 v[96:111], v[52:55], v[64:67], v[96:111]
    buffer_load_dwordx4 v23, s[16:19], s41 offen offset:3072 lds
    s_waitcnt lgkmcnt(0)
    v_mfma_f32_32x32x16_bf16 v[80:95], v[56:59], v[72:75], v[80:95]
    ds_read_b128 v[48:51], v30 offset:0
    ds_read_b128 v[64:67], v38 offset:0
    v_mfma_f32_32x32x16_bf16 v[112:127], v[56:59], v[76:79], v[112:127]
    ds_read_b128 v[68:71], v38 offset:8192
    ds_read_b128 v[52:55], v30 offset:4096
    s_cmp_eq_u32 s57, 6
    s_cbranch_scc0 L_nx_7
    ds_read_b128 v[176:179], v144 offset:0
    ds_read_b128 v[180:183], v145 offset:0
    ds_read_b128 v[184:187], v146 offset:512
    ds_read_b128 v[188:191], v147 offset:512
L_nx_7:
    v_mfma_f32_32x32x16_bf16 v[128:143], v[60:63], v[76:79], v[128:143]
    v_mfma_f32_32x32x16_bf16 v[96:111], v[60:63], v[72:75], v[96:111]
    s_waitcnt lgkmcnt(0)
    v_mfma_f32_32x32x16_bf16 v[80:95], v[48:51], v[64:67], v[80:95]
    ds_read_b128 v[56:59], v31 offset:0
    ds_read_b128 v[72:75], v39 offset:0
    v_mfma_f32_32x32x16_bf16 v[112:127], v[48:51], v[68:71], v[112:127]
    ds_read_b128 v[76:79], v39 offset:8192
    ds_read_b128 v[60:63], v31 offset:4096
    v_mfma_f32_32x32x16_bf16 v[128:143], v[52:55], v[68:71], v[128:143]
    v_mfma_f32_32x32x16_bf16 v[96:111], v[52:55], v[64:67], v[96:111]
    s_waitcnt vmcnt(10) lgkmcnt(0)
    v_mfma_f32_32x32x16_bf16 v[80:95], v[56:59], v[72:75], v[80:95]
    s_barrier
    ds_read_b128 v[48:51], v28 offset:32768
    ds_read_b128 v[64:67], v36 offset:32768
    v_mfma_f32_32x32x16_bf16 v[112:127], v[56:59], v[76:79], v[112:127]
    ds_read_b128 v[68:71], v36 offset:40960
    ds_read_b128 v[52:55], v28 offset:36864
    v_mfma_f32_32x32x16_bf16 v[128:143], v[60:63], v[76:79], v[128:143]
    v_mfma_f32_32x32x16_bf16 v[96:111], v[60:63], v[72:75], v[96:111]
    s_waitcnt lgkmcnt(0)
    v_mfma_f32_32x32x16_bf16 v[80:95], v[48:51], v[64:67], v[80:95]
    ds_read_b128 v[56:59], v29 offset:32768
    ds_read_b128 v[72:75], v37 offset:32768
    v_mfma_f32_32x32x16_bf16 v[112:127], v[48:51], v[68:71], v[112:127]
    ds_read_b128 v[76:79], v37 offset:40960
    ds_read_b128 v[60:63], v29 offset:36864
    v_mfma_f32_32x32x16_bf16 v[128:143], v[52:55], v[68:71], v[128:143]
    v_mfma_f32_32x32x16_bf16 v[96:111], v[52:55], v[64:67], v[96:111]
    s_waitcnt lgkmcnt(0)
    v_mfma_f32_32x32x16_bf16 v[80:95], v[56:59], v[72:75], v[80:95]
    ds_read_b128 v[48:51], v30 offset:32768
    ds_read_b128 v[64:67], v38 offset:32768
    v_mfma_f32_32x32x16_bf16 v[112:127], v[56:59], v[76:79], v[112:127]
    ds_read_b128 v[68:71], v38 offset:40960
    ds_read_b128 v[52:55], v30 offset:36864
    s_cmp_eq_u32 s57, 7
    s_cbranch_scc0 L_nx_8
    ds_read_b128 v[176:179], v144 offset:0
    ds_read_b128 v[180:183], v145 offset:0
    ds_read_b128 v[184:187], v146 offset:512
    ds_read_b128 v[188:191], v147 offset:512
L_nx_8:
    v_mfma_f32_32x32x16_bf16 v[128:143], v[60:63], v[76:79], v[128:143]
    v_mfma_f32_32x32x16_bf16 v[96:111], v[60:63], v[72:75], v[96:111]
    s_waitcnt lgkmcnt(0)
    v_mfma_f32_32x32x16_bf16 v[80:95], v[48:51], v[64:67], v[80:95]
    ds_read_b128 v[56:59], v31 offset:32768
    ds_read_b128 v[72:75], v39 offset:32768
    v_mfma_f32_32x32x16_bf16 v[112:127], v[48:51], v[68:71], v[112:127]
    ds_read_b128 v[76:79], v39 offset:40960
    ds_read_b128 v[60:63], v31 offset:36864
    v_mfma_f32_32x32x16_bf16 v[128:143], v[52:55], v[68:71], v[128:143]
    v_mfma_f32_32x32x16_bf16 v[96:111], v[52:55], v[64:67], v[96:111]
    s_waitcnt lgkmcnt(0)
    v_mfma_f32_32x32x16_bf16 v[80:95], v[56:59], v[72:75], v[80:95]
    s_barrier
    v_mfma_f32_32x32x16_bf16 v[112:127], v[56:59], v[76:79], v[112:127]
    v_mfma_f32_32x32x16_bf16 v[128:143], v[60:63], v[76:79], v[128:143]
    v_mfma_f32_32x32x16_bf16 v[96:111], v[60:63], v[72:75], v[96:111]
    s_nop 9
    s_nop 0
    v_pk_fma_f32 v[228:229], v[208:209], v[112:113], v[82:83] op_sel:[1,0,0] op_sel_hi:[1,1,1] neg_lo:[1,0,0] neg_hi:[1,0,0]
    v_pk_fma_f32 v[230:231], v[208:209], v[80:81], v[114:115] op_sel:[1,0,0] op_sel_hi:[1,1,1]
    v_pk_fma_f32 v[228:229], v[208:209], v[80:81], v[228:229] op_sel:[0,0,0] op_sel_hi:[0,1,1]
    v_pk_fma_f32 v[230:231], v[208:209], v[112:113], v[230:231] op_sel:[0,0,0] op_sel_hi:[0,1,1]
    v_pk_fma_f32 v[224:225], v[208:209], v[230:231], v[84:85] op_sel:[1,0,0] op_sel_hi:[1,1,1] neg_lo:[1,0,0] neg_hi:[1,0,0]
    v_pk_fma_f32 v[226:227], v[208:209], v[228:229], v[116:117] op_sel:[1,0,0] op_sel_hi:[1,1,1]
    v_pk_fma_f32 v[224:225], v[208:209], v[228:229], v[224:225] op_sel:[0,0,0] op_sel_hi:[0,1,1]
    v_pk_fma_f32 v[226:227], v[208:209], v[230:231], v[226:227] op_sel:[0,0,0] op_sel_hi:[0,1,1]
    v_pk_fma_f32 v[228:229], v[208:209], v[226:227], v[86:87] op_sel:[1,0,0] op_sel_hi:[1,1,1] neg_lo:[1,0,0] neg_hi:[1,0,0]
    v_pk_fma_f32 v[230:231], v[208:209], v[224:225], v[118:119] op_sel:[1,0,0] op_sel_hi:[1,1,1]
    v_pk_fma_f32 v[228:229], v[208:209], v[224:225], v[228:229] op_sel:[0,0,0] op_sel_hi:[0,1,1]
    v_pk_fma_f32 v[230:231], v[208:209], v[226:227], v[230:231] op_sel:[0,0,0] op_sel_hi:[0,1,1]
    v_pk_fma_f32 v[224:225], v[208:209], v[230:231], v[88:89] op_sel:[1,0,0] op_sel_hi:[1,1,1] neg_lo:[1,0,0] neg_hi:[1,0,0]
    v_pk_fma_f32 v[226:227], v[208:209], v[228:229], v[120:121] op_sel:[1,0,0] op_sel_hi:[1,1,1]
    v_pk_fma_f32 v[224:225], v[208:209], v[228:229], v[224:225] op_sel:[0,0,0] op_sel_hi:[0,1,1]
    v_pk_fma_f32 v[226:227], v[208:209], v[230:231], v[226:227] op_sel:[0,0,0] op_sel_hi:[0,1,1]
    v_pk_fma_f32 v[228:229], v[208:209], v[226:227], v[90:91] op_sel:[1,0,0] op_sel_hi:[1,1,1] neg_lo:[1,0,0] neg_hi:[1,0,0]
    v_pk_fma_f32 v[230:231], v[208:209], v[224:225], v[122:123] op_sel:[1,0,0] op_sel_hi:[1,1,1]
    v_pk_fma_f32 v[228:229], v[208:209], v[224:225], v[228:229] op_sel:[0,0,0] op_sel_hi:[0,1,1]
    v_pk_fma_f32 v[230:231], v[208:209], v[226:227], v[230:231] op_sel:[0,0,0] op_sel_hi:[0,1,1]
    v_pk_fma_f32 v[224:225], v[208:209], v[230:231], v[92:93] op_sel:[1,0,0] op_sel_hi:[1,1,1] neg_lo:[1,0,0] neg_hi:[1,0,0]
    v_pk_fma_f32 v[226:227], v[208:209], v[228:229], v[124:125] op_sel:[1,0,0] op_sel_hi:[1,1,1]
    v_pk_fma_f32 v[224:225], v[208:209], v[228:229], v[224:225] op_sel:[0,0,0] op_sel_hi:[0,1,1]
    v_pk_fma_f32 v[226:227], v[208:209], v[230:231], v[226:227] op_sel:[0,0,0] op_sel_hi:[0,1,1]
    v_pk_fma_f32 v[228:229], v[208:209], v[226:227], v[94:95] op_sel:[1,0,0] op_sel_hi:[1,1,1] neg_lo:[1,0,0] neg_hi:[1,0,0]
    v_pk_fma_f32 v[230:231], v[208:209], v[224:225], v[126:127] op_sel:[1,0,0] op_sel_hi:[1,1,1]
    v_pk_fma_f32 v[228:229], v[208:209], v[224:225], v[228:229] op_sel:[0,0,0] op_sel_hi:[0,1,1]
    v_pk_fma_f32 v[230:231], v[208:209], v[226:227], v[230:231] op_sel:[0,0,0] op_sel_hi:[0,1,1]
    v_pk_fma_f32 v[224:225], v[208:209], v[230:231], v[96:97] op_sel:[1,0,0] op_sel_hi:[1,1,1] neg_lo:[1,0,0] neg_hi:[1,0,0]
    v_pk_fma_f32 v[226:227], v[208:209], v[228:229], v[128:129] op_sel:[1,0,0] op_sel_hi:[1,1,1]
    v_pk_fma_f32 v[224:225], v[208:209], v[228:229], v[224:225] op_sel:[0,0,0] op_sel_hi:[0,1,1]
    v_pk_fma_f32 v[226:227], v[208:209], v[230:231], v[226:227] op_sel:[0,0,0] op_sel_hi:[0,1,1]
    v_pk_fma_f32 v[228:229], v[208:209], v[226:227], v[98:99] op_sel:[1,0,0] op_sel_hi:[1,1,1] neg_lo:[1,0,0] neg_hi:[1,0,0]
    v_pk_fma_f32 v[230:231], v[208:209], v[224:225], v[130:131] op_sel:[1,0,0] op_sel_hi:[1,1,1]
    v_pk_fma_f32 v[228:229], v[208:209], v[224:225], v[228:229] op_sel:[0,0,0] op_sel_hi:[0,1,1]
    v_pk_fma_f32 v[230:231], v[208:209], v[226:227], v[230:231] op_sel:[0,0,0] op_sel_hi:[0,1,1]
    v_pk_fma_f32 v[224:225], v[208:209], v[230:231], v[100:101] op_sel:[1,0,0] op_sel_hi:[1,1,1] neg_lo:[1,0,0] neg_hi:[1,0,0]
    v_pk_fma_f32 v[226:227], v[208:209], v[228:229], v[132:133] op_sel:[1,0,0] op_sel_hi:[1,1,1]
    v_pk_fma_f32 v[224:225], v[208:209], v[228:229], v[224:225] op_sel:[0,0,0] op_sel_hi:[0,1,1]
    v_pk_fma_f32 v[226:227], v[208:209], v[230:231], v[226:227] op_sel:[0,0,0] op_sel_hi:[0,1,1]
    v_pk_fma_f32 v[228:229], v[208:209], v[226:227], v[102:103] op_sel:[1,0,0] op_sel_hi:[1,1,1] neg_lo:[1,0,0] neg_hi:[1,0,0]
    v_pk_fma_f32 v[230:231], v[208:209], v[224:225], v[134:135] op_sel:[1,0,0] op_sel_hi:[1,1,1]
    v_pk_fma_f32 v[228:229], v[208:209], v[224:225], v[228:229] op_sel:[0,0,0] op_sel_hi:[0,1,1]
    v_pk_fma_f32 v[230:231], v[208:209], v[226:227], v[230:231] op_sel:[0,0,0] op_sel_hi:[0,1,1]
    v_pk_fma_f32 v[224:225], v[208:209], v[230:231], v[104:105] op_sel:[1,0,0] op_sel_hi:[1,1,1] neg_lo:[1,0,0] neg_hi:[1,0,0]
    v_pk_fma_f32 v[226:227], v[208:209], v[228:229], v[136:137] op_sel:[1,0,0] op_sel_hi:[1,1,1]
    v_pk_fma_f32 v[224:225], v[208:209], v[228:229], v[224:225] op_sel:[0,0,0] op_sel_hi:[0,1,1]
    v_pk_fma_f32 v[226:227], v[208:209], v[230:231], v[226:227] op_sel:[0,0,0] op_sel_hi:[0,1,1]
    v_pk_fma_f32 v[228:229], v[208:209], v[226:227], v[106:107] op_sel:[1,0,0] op_sel_hi:[1,1,1] neg_lo:[1,0,0] neg_hi:[1,0,0]
    v_pk_fma_f32 v[230:231], v[208:209], v[224:225], v[138:139] op_sel:[1,0,0] op_sel_hi:[1,1,1]
    v_pk_fma_f32 v[228:229], v[208:209], v[224:225], v[228:229] op_sel:[0,0,0] op_sel_hi:[0,1,1]
    v_pk_fma_f32 v[230:231], v[208:209], v[226:227], v[230:231] op_sel:[0,0,0] op_sel_hi:[0,1,1]
    v_pk_fma_f32 v[224:225], v[208:209], v[230:231], v[108:109] op_sel:[1,0,0] op_sel_hi:[1,1,1] neg_lo:[1,0,0] neg_hi:[1,0,0]
    v_pk_fma_f32 v[226:227], v[208:209], v[228:229], v[140:141] op_sel:[1,0,0] op_sel_hi:[1,1,1]
    v_pk_fma_f32 v[224:225], v[208:209], v[228:229], v[224:225] op_sel:[0,0,0] op_sel_hi:[0,1,1]
    v_pk_fma_f32 v[226:227], v[208:209], v[230:231], v[226:227] op_sel:[0,0,0] op_sel_hi:[0,1,1]
    v_pk_fma_f32 v[228:229], v[208:209], v[226:227], v[110:111] op_sel:[1,0,0] op_sel_hi:[1,1,1] neg_lo:[1,0,0] neg_hi:[1,0,0]
    v_pk_fma_f32 v[230:231], v[208:209], v[224:225], v[142:143] op_sel:[1,0,0] op_sel_hi:[1,1,1]
    v_pk_fma_f32 v[228:229], v[208:209], v[224:225], v[228:229] op_sel:[0,0,0] op_sel_hi:[0,1,1]
    v_pk_fma_f32 v[230:231], v[208:209], v[226:227], v[230:231] op_sel:[0,0,0] op_sel_hi:[0,1,1]
    v_fma_f32 v234, v210, v228, v229
    v_fma_f32 v235, v210, v230, v231
    v_fma_f32 v234, -v211, v230, v234
    v_fma_f32 v235, v211, v228, v235
    ds_write_b64 v3, v[234:235]
    v_mov_b32 v232, v228
    v_mov_b32 v233, v230
    v_pk_mul_f32 v[226:227], v[220:221], v[80:81] op_sel:[1,0] op_sel_hi:[1,1] neg_lo:[1,0] neg_hi:[1,0]
    v_pk_mul_f32 v[80:81], v[220:221], v[80:81] op_sel:[0,0] op_sel_hi:[0,1]
    v_pk_fma_f32 v[80:81], v[220:221], v[112:113], v[80:81] op_sel:[1,0,0] op_sel_hi:[1,1,1] neg_lo:[1,0,0] neg_hi:[1,0,0]
    v_pk_fma_f32 v[112:113], v[220:221], v[112:113], v[226:227] op_sel:[0,0,0] op_sel_hi:[0,1,1] neg_lo:[1,0,0] neg_hi:[1,0,0]
    v_pk_mul_f32 v[228:229], v[220:221], v[82:83] op_sel:[1,0] op_sel_hi:[1,1] neg_lo:[1,0] neg_hi:[1,0]
    v_pk_mul_f32 v[82:83], v[220:221], v[82:83] op_sel:[0,0] op_sel_hi:[0,1]
    v_pk_fma_f32 v[82:83], v[220:221], v[114:115], v[82:83] op_sel:[1,0,0] op_sel_hi:[1,1,1] neg_lo:[1,0,0] neg_hi:[1,0,0]
    v_pk_fma_f32 v[114:115], v[220:221], v[114:115], v[228:229] op_sel:[0,0,0] op_sel_hi:[0,1,1] neg_lo:[1,0,0] neg_hi:[1,0,0]
    s_waitcnt lgkmcnt(0)
    s_barrier
    ds_read_b64 v[236:237], v4 offset:0
    ds_read_b64 v[238:239], v4 offset:512
    ds_read_b64 v[240:241], v4 offset:1024
    ds_read_b64 v[242:243], v4 offset:1536
    v_pk_mul_f32 v[226:227], v[220:221], v[84:85] op_sel:[1,0] op_sel_hi:[1,1] neg_lo:[1,0] neg_hi:[1,0]
    v_pk_mul_f32 v[84:85], v[220:221], v[84:85] op_sel:[0,0] op_sel_hi:[0,1]
    v_pk_fma_f32 v[84:85], v[220:221], v[116:117], v[84:85] op_sel:[1,0,0] op_sel_hi:[1,1,1] neg_lo:[1,0,0] neg_hi:[1,0,0]
    v_pk_fma_f32 v[116:117], v[220:221], v[116:117], v[226:227] op_sel:[0,0,0] op_sel_hi:[0,1,1] neg_lo:[1,0,0] neg_hi:[1,0,0]
    v_pk_mul_f32 v[228:229], v[220:221], v[86:87] op_sel:[1,0] op_sel_hi:[1,1] neg_lo:[1,0] neg_hi:[1,0]
    v_pk_mul_f32 v[86:87], v[220:221], v[86:87] op_sel:[0,0] op_sel_hi:[0,1]
    v_pk_fma_f32 v[86:87], v[220:221], v[118:119], v[86:87] op_sel:[1,0,0] op_sel_hi:[1,1,1] neg_lo:[1,0,0] neg_hi:[1,0,0]
    v_pk_fma_f32 v[118:119], v[220:221], v[118:119], v[228:229] op_sel:[0,0,0] op_sel_hi:[0,1,1] neg_lo:[1,0,0] neg_hi:[1,0,0]
    v_pk_mul_f32 v[226:227], v[220:221], v[88:89] op_sel:[1,0] op_sel_hi:[1,1] neg_lo:[1,0] neg_hi:[1,0]
    v_pk_mul_f32 v[88:89], v[220:221], v[88:89] op_sel:[0,0] op_sel_hi:[0,1]
    v_pk_fma_f32 v[88:89], v[220:221], v[120:121], v[88:89] op_sel:[1,0,0] op_sel_hi:[1,1,1] neg_lo:[1,0,0] neg_hi:[1,0,0]
    v_pk_fma_f32 v[120:121], v[220:221], v[120:121], v[226:227] op_sel:[0,0,0] op_sel_hi:[0,1,1] neg_lo:[1,0,0] neg_hi:[1,0,0]
    v_pk_mul_f32 v[228:229], v[220:221], v[90:91] op_sel:[1,0] op_sel_hi:[1,1] neg_lo:[1,0] neg_hi:[1,0]
    v_pk_mul_f32 v[90:91], v[220:221], v[90:91] op_sel:[0,0] op_sel_hi:[0,1]
    v_pk_fma_f32 v[90:91], v[220:221], v[122:123], v[90:91] op_sel:[1,0,0] op_sel_hi:[1,1,1] neg_lo:[1,0,0] neg_hi:[1,0,0]
    v_pk_fma_f32 v[122:123], v[220:221], v[122:123], v[228:229] op_sel:[0,0,0] op_sel_hi:[0,1,1] neg_lo:[1,0,0] neg_hi:[1,0,0]
    s_waitcnt lgkmcnt(0)
    s_nop 0
    v_pk_fma_f32 v[252:253], v[212:213], v[236:237], v[238:239] op_sel:[1,1,0] op_sel_hi:[1,0,1] neg_lo:[1,0,0]
    v_pk_fma_f32 v[244:245], v[212:213], v[236:237], v[252:253] op_sel:[0,0,0] op_sel_hi:[0,1,1]
    v_pk_fma_f32 v[252:253], v[212:213], v[244:245], v[240:241] op_sel:[1,1,0] op_sel_hi:[1,0,1] neg_lo:[1,0,0]
    v_pk_fma_f32 v[246:247], v[212:213], v[244:245], v[252:253] op_sel:[0,0,0] op_sel_hi:[0,1,1]
    v_pk_fma_f32 v[252:253], v[212:213], v[246:247], v[242:243] op_sel:[1,1,0] op_sel_hi:[1,0,1] neg_lo:[1,0,0]
    v_pk_fma_f32 v[252:253], v[212:213], v[246:247], v[252:253] op_sel:[0,0,0] op_sel_hi:[0,1,1]
    v_and_or_b32 v248, v252, s76, v8
    v_and_or_b32 v249, v253, s76, v8
    buffer_store_dwordx2 v[248:249], v45, s[20:23], s73 offen sc1
    v_pk_mul_f32 v[226:227], v[220:221], v[92:93] op_sel:[1,0] op_sel_hi:[1,1] neg_lo:[1,0] neg_hi:[1,0]
    v_pk_mul_f32 v[92:93], v[220:221], v[92:93] op_sel:[0,0] op_sel_hi:[0,1]
    v_pk_fma_f32 v[92:93], v[220:221], v[124:125], v[92:93] op_sel:[1,0,0] op_sel_hi:[1,1,1] neg_lo:[1,0,0] neg_hi:[1,0,0]
    v_pk_fma_f32 v[124:125], v[220:221], v[124:125], v[226:227] op_sel:[0,0,0] op_sel_hi:[0,1,1] neg_lo:[1,0,0] neg_hi:[1,0,0]
    v_pk_mul_f32 v[228:229], v[220:221], v[94:95] op_sel:[1,0] op_sel_hi:[1,1] neg_lo:[1,0] neg_hi:[1,0]
    v_pk_mul_f32 v[94:95], v[220:221], v[94:95] op_sel:[0,0] op_sel_hi:[0,1]
    v_pk_fma_f32 v[94:95], v[220:221], v[126:127], v[94:95] op_sel:[1,0,0] op_sel_hi:[1,1,1] neg_lo:[1,0,0] neg_hi:[1,0,0]
    v_pk_fma_f32 v[126:127], v[220:221], v[126:127], v[228:229] op_sel:[0,0,0] op_sel_hi:[0,1,1] neg_lo:[1,0,0] neg_hi:[1,0,0]
    v_pk_mul_f32 v[226:227], v[220:221], v[96:97] op_sel:[1,0] op_sel_hi:[1,1] neg_lo:[1,0] neg_hi:[1,0]
    v_pk_mul_f32 v[96:97], v[220:221], v[96:97] op_sel:[0,0] op_sel_hi:[0,1]
    v_pk_fma_f32 v[96:97], v[220:221], v[128:129], v[96:97] op_sel:[1,0,0] op_sel_hi:[1,1,1] neg_lo:[1,0,0] neg_hi:[1,0,0]
    v_pk_fma_f32 v[128:129], v[220:221], v[128:129], v[226:227] op_sel:[0,0,0] op_sel_hi:[0,1,1] neg_lo:[1,0,0] neg_hi:[1,0,0]
    v_pk_mul_f32 v[228:229], v[220:221], v[98:99] op_sel:[1,0] op_sel_hi:[1,1] neg_lo:[1,0] neg_hi:[1,0]
    v_pk_mul_f32 v[98:99], v[220:221], v[98:99] op_sel:[0,0] op_sel_hi:[0,1]
    v_pk_fma_f32 v[98:99], v[220:221], v[130:131], v[98:99] op_sel:[1,0,0] op_sel_hi:[1,1,1] neg_lo:[1,0,0] neg_hi:[1,0,0]
    v_pk_fma_f32 v[130:131], v[220:221], v[130:131], v[228:229] op_sel:[0,0,0] op_sel_hi:[0,1,1] neg_lo:[1,0,0] neg_hi:[1,0,0]
    v_pk_mul_f32 v[226:227], v[220:221], v[100:101] op_sel:[1,0] op_sel_hi:[1,1] neg_lo:[1,0] neg_hi:[1,0]
    v_pk_mul_f32 v[100:101], v[220:221], v[100:101] op_sel:[0,0] op_sel_hi:[0,1]
    v_pk_fma_f32 v[100:101], v[220:221], v[132:133], v[100:101] op_sel:[1,0,0] op_sel_hi:[1,1,1] neg_lo:[1,0,0] neg_hi:[1,0,0]
    v_pk_fma_f32 v[132:133], v[220:221], v[132:133], v[226:227] op_sel:[0,0,0] op_sel_hi:[0,1,1] neg_lo:[1,0,0] neg_hi:[1,0,0]
    v_pk_mul_f32 v[228:229], v[220:221], v[102:103] op_sel:[1,0] op_sel_hi:[1,1] neg_lo:[1,0] neg_hi:[1,0]
    v_pk_mul_f32 v[102:103], v[220:221], v[102:103] op_sel:[0,0] op_sel_hi:[0,1]
    v_pk_fma_f32 v[102:103], v[220:221], v[134:135], v[102:103] op_sel:[1,0,0] op_sel_hi:[1,1,1] neg_lo:[1,0,0] neg_hi:[1,0,0]
    v_pk_fma_f32 v[134:135], v[220:221], v[134:135], v[228:229] op_sel:[0,0,0] op_sel_hi:[0,1,1] neg_lo:[1,0,0] neg_hi:[1,0,0]
    v_pk_mul_f32 v[226:227], v[220:221], v[104:105] op_sel:[1,0] op_sel_hi:[1,1] neg_lo:[1,0] neg_hi:[1,0]
    v_pk_mul_f32 v[104:105], v[220:221], v[104:105] op_sel:[0,0] op_sel_hi:[0,1]
    v_pk_fma_f32 v[104:105], v[220:221], v[136:137], v[104:105] op_sel:[1,0,0] op_sel_hi:[1,1,1] neg_lo:[1,0,0] neg_hi:[1,0,0]
    v_pk_fma_f32 v[136:137], v[220:221], v[136:137], v[226:227] op_sel:[0,0,0] op_sel_hi:[0,1,1] neg_lo:[1,0,0] neg_hi:[1,0,0]
    v_pk_mul_f32 v[228:229], v[220:221], v[106:107] op_sel:[1,0] op_sel_hi:[1,1] neg_lo:[1,0] neg_hi:[1,0]
    v_pk_mul_f32 v[106:107], v[220:221], v[106:107] op_sel:[0,0] op_sel_hi:[0,1]
    v_pk_fma_f32 v[106:107], v[220:221], v[138:139], v[106:107] op_sel:[1,0,0] op_sel_hi:[1,1,1] neg_lo:[1,0,0] neg_hi:[1,0,0]
    v_pk_fma_f32 v[138:139], v[220:221], v[138:139], v[228:229] op_sel:[0,0,0] op_sel_hi:[0,1,1] neg_lo:[1,0,0] neg_hi:[1,0,0]
    v_pk_mul_f32 v[226:227], v[220:221], v[108:109] op_sel:[1,0] op_sel_hi:[1,1] neg_lo:[1,0] neg_hi:[1,0]
    v_pk_mul_f32 v[108:109], v[220:221], v[108:109] op_sel:[0,0] op_sel_hi:[0,1]
    v_pk_fma_f32 v[108:109], v[220:221], v[140:141], v[108:109] op_sel:[1,0,0] op_sel_hi:[1,1,1] neg_lo:[1,0,0] neg_hi:[1,0,0]
    v_pk_fma_f32 v[140:141], v[220:221], v[140:141], v[226:227] op_sel:[0,0,0] op_sel_hi:[0,1,1] neg_lo:[1,0,0] neg_hi:[1,0,0]
    v_pk_mul_f32 v[228:229], v[220:221], v[110:111] op_sel:[1,0] op_sel_hi:[1,1] neg_lo:[1,0] neg_hi:[1,0]
    v_pk_mul_f32 v[110:111], v[220:221], v[110:111] op_sel:[0,0] op_sel_hi:[0,1]
    v_pk_fma_f32 v[110:111], v[220:221], v[142:143], v[110:111] op_sel:[1,0,0] op_sel_hi:[1,1,1] neg_lo:[1,0,0] neg_hi:[1,0,0]
    v_pk_fma_f32 v[142:143], v[220:221], v[142:143], v[228:229] op_sel:[0,0,0] op_sel_hi:[0,1,1] neg_lo:[1,0,0] neg_hi:[1,0,0]
    v_cndmask_b32_e64 v226, 0, v236, s[50:51]
    v_cndmask_b32_e64 v228, v244, v246, s[50:51]
    v_cndmask_b32_e64 v224, v226, v228, s[52:53]
    v_cndmask_b32_e64 v227, 0, v237, s[50:51]
    v_cndmask_b32_e64 v229, v245, v247, s[50:51]
    v_cndmask_b32_e64 v225, v227, v229, s[52:53]
    v_pk_fma_f32 v[252:253], v[210:211], v[224:225], v[232:233] op_sel:[1,1,0] op_sel_hi:[1,0,1] neg_lo:[1,0,0]
    v_pk_fma_f32 v[244:245], v[210:211], v[224:225], v[252:253] op_sel:[0,0,0] op_sel_hi:[0,1,1]
    v_pk_mul_f32 v[252:253], v[220:221], v[244:245] op_sel:[1,1] op_sel_hi:[1,0] neg_lo:[1,0]
    v_pk_fma_f32 v[242:243], v[220:221], v[244:245], v[252:253] op_sel:[0,0,0] op_sel_hi:[0,1,1]
    v_pk_mul_f32 v[252:253], v[220:221], v[224:225] op_sel:[1,1] op_sel_hi:[1,0] neg_lo:[1,0]
    v_pk_fma_f32 v[238:239], v[220:221], v[224:225], v[252:253] op_sel:[0,0,0] op_sel_hi:[0,1,1]
    v_pk_mul_f32 v[252:253], v[220:221], v[216:217] op_sel:[1,1] op_sel_hi:[1,0] neg_lo:[1,0]
    v_pk_fma_f32 v[236:237], v[220:221], v[216:217], v[252:253] op_sel:[0,0,0] op_sel_hi:[0,1,1]
    v_pk_mul_f32 v[252:253], v[236:237], v[210:211] op_sel:[1,1] op_sel_hi:[1,0] neg_lo:[1,0]
    v_pk_fma_f32 v[240:241], v[236:237], v[210:211], v[252:253] op_sel:[0,0,0] op_sel_hi:[0,1,1]
    v_bfe_u32 v9, v1, 4, 1
    v_bfe_u32 v13, v1, 1, 1
    v_lshl_add_u32 v9, v9, 1, v13
    v_bfe_u32 v13, v1, 2, 2
    v_lshl_add_u32 v13, v6, 3, v13
    v_lshlrev_b32 v14, 2, v9
    v_xor_b32 v13, v13, v14
    v_lshlrev_b32 v13, 4, v13
    v_lshl_add_u32 v13, v9, 9, v13
    v_and_b32 v14, 1, v1
    v_lshl_add_u32 v13, v14, 3, v13
    s_lshl_b32 s34, s28, 13
    v_add_u32_e64 v24, s34, v13
    v_xor_b32 v25, 64, v24
    v_add_u32 v26, 0x10000, v24
    v_add_u32 v27, 0x10000, v25
    v_add_u32 v28, 0x20000, v24
    v_add_u32 v29, 0x20000, v25
    v_xor_b32_e64 v249, 64, v223
    v_xor_b32 v250, 128, v223
    v_xor_b32 v251, 192, v223
    s_add_u32 s12, s20, s72
    s_addc_u32 s13, s21, 0
    s_mov_b32 s14, 8192
    s_add_u32 m0, s48, 0x0
    s_and_b32 s41, s4, 3
    s_cmp_eq_u32 s41, 3
    s_cselect_b32 s41, 0x24000, 0x0
    s_cselect_b32 s39, s44, s62
    s_add_u32 m0, s48, s41
    s_lshl_b32 s41, s39, 7
    buffer_load_dwordx4 v20, s[16:19], s41 offen offset:0 lds
    buffer_load_dwordx4 v21, s[16:19], s41 offen offset:1024 lds
    buffer_load_dwordx4 v22, s[16:19], s41 offen offset:2048 lds
    buffer_load_dwordx4 v23, s[16:19], s41 offen offset:3072 lds
    s_add_u32 m0, s48, 0x4000
    s_lshl_b32 s41, s45, 7
    buffer_load_dwordx4 v20, s[16:19], s41 offen offset:0 lds
    buffer_load_dwordx4 v21, s[16:19], s41 offen offset:1024 lds
    buffer_load_dwordx4 v22, s[16:19], s41 offen offset:2048 lds
    buffer_load_dwordx4 v23, s[16:19], s41 offen offset:3072 lds
    s_add_u32 m0, s48, 0x8000
    s_lshl_b32 s41, s86, 7
    buffer_load_dwordx4 v20, s[16:19], s41 offen offset:0 lds
    buffer_load_dwordx4 v21, s[16:19], s41 offen offset:1024 lds
    buffer_load_dwordx4 v22, s[16:19], s41 offen offset:2048 lds
    buffer_load_dwordx4 v23, s[16:19], s41 offen offset:3072 lds
    v_mfma_f32_32x32x16_bf16 v[144:159], v[176:179], v[192:195], 0
    v_mfma_f32_32x32x16_bf16 v[160:175], v[184:187], v[192:195], 0
    v_mfma_f32_32x32x16_bf16 v[144:159], v[180:183], v[196:199], v[144:159]
    v_mfma_f32_32x32x16_bf16 v[160:175], v[188:191], v[196:199], v[160:175]
    buffer_load_dwordx2 v[48:49], v44, s[12:15], 0 offen offset:0 sc1
    buffer_load_dwordx2 v[50:51], v44, s[12:15], 0 offen offset:512 sc1
    buffer_load_dwordx2 v[52:53], v44, s[12:15], 0 offen offset:1024 sc1
    buffer_load_dwordx2 v[54:55], v44, s[12:15], 0 offen offset:1536 sc1
    buffer_load_dwordx2 v[56:57], v44, s[12:15], 0 offen offset:2048 sc1
    buffer_load_dwordx2 v[58:59], v44, s[12:15], 0 offen offset:2560 sc1
    buffer_load_dwordx2 v[60:61], v44, s[12:15], 0 offen offset:3072 sc1
    buffer_load_dwordx2 v[62:63], v44, s[12:15], 0 offen offset:3584 sc1
    buffer_load_dword v254, v12, s[20:23], s64 offen offset:64 sc1
    buffer_load_dword v14, v15, s[20:23], s66 offen sc1
    s_add_u32 m0, s48, 0xc000
    s_lshl_b32 s41, s87, 7
    buffer_load_dwordx4 v20, s[16:19], s41 offen offset:0 lds
    buffer_load_dwordx4 v21, s[16:19], s41 offen offset:1024 lds
    buffer_load_dwordx4 v22, s[16:19], s41 offen offset:2048 lds
    buffer_load_dwordx4 v23, s[16:19], s41 offen offset:3072 lds
    s_add_u32 m0, s48, 0x10000
    s_lshl_b32 s41, s94, 7
    buffer_load_dwordx4 v20, s[16:19], s41 offen offset:0 lds
    buffer_load_dwordx4 v21, s[16:19], s41 offen offset:1024 lds
    buffer_load_dwordx4 v22, s[16:19], s41 offen offset:2048 lds
    buffer_load_dwordx4 v23, s[16:19], s41 offen offset:3072 lds
    s_add_u32 m0, s48, 0x14000
    s_lshl_b32 s41, s95, 7
    buffer_load_dwordx4 v20, s[16:19], s41 offen offset:0 lds
    buffer_load_dwordx4 v21, s[16:19], s41 offen offset:1024 lds
    buffer_load_dwordx4 v22, s[16:19], s41 offen offset:2048 lds
    buffer_load_dwordx4 v23, s[16:19], s41 offen offset:3072 lds
    s_waitcnt vmcnt(12)
    v_xor_b32_e64 v13, v48, v200
    v_bitop3_b32 v13, v50, v201, v13 bitop3:0xbe
    v_bitop3_b32 v13, v52, v202, v13 bitop3:0xbe
    v_bitop3_b32 v13, v54, v203, v13 bitop3:0xbe
    v_bitop3_b32 v13, v56, v204, v13 bitop3:0xbe
    v_bitop3_b32 v13, v58, v205, v13 bitop3:0xbe
    v_bitop3_b32 v13, v60, v206, v13 bitop3:0xbe
    v_bitop3_b32 v13, v62, v207, v13 bitop3:0xbe
    v_xor_b32 v14, s91, v14
    v_lshrrev_b32 v9, 4, v14
    v_and_b32 v13, 0xff, v13
    v_or_b32 v13, v13, v9
    v_cmp_ne_u32 s[58:59], 0, v13
    s_nop 0
    s_cmp_eq_u64 s[58:59], 0
    s_cbranch_scc1 L_ok1_9
    s_mov_b32 s56, 16384
L_poll_10:
    buffer_load_dwordx2 v[48:49], v44, s[12:15], 0 offen offset:0 sc1
    buffer_load_dwordx2 v[50:51], v44, s[12:15], 0 offen offset:512 sc1
    buffer_load_dwordx2 v[52:53], v44, s[12:15], 0 offen offset:1024 sc1
    buffer_load_dwordx2 v[54:55], v44, s[12:15], 0 offen offset:1536 sc1
    buffer_load_dwordx2 v[56:57], v44, s[12:15], 0 offen offset:2048 sc1
    buffer_load_dwordx2 v[58:59], v44, s[12:15], 0 offen offset:2560 sc1
    buffer_load_dwordx2 v[60:61], v44, s[12:15], 0 offen offset:3072 sc1
    buffer_load_dwordx2 v[62:63], v44, s[12:15], 0 offen offset:3584 sc1
    buffer_load_dword v254, v12, s[20:23], s64 offen offset:64 sc1
    buffer_load_dword v14, v15, s[20:23], s66 offen sc1
    s_waitcnt vmcnt(0)
    v_xor_b32 v13, v48, v200
    v_bitop3_b32 v13, v50, v201, v13 bitop3:0xbe
    v_bitop3_b32 v13, v52, v202, v13 bitop3:0xbe
    v_bitop3_b32 v13, v54, v203, v13 bitop3:0xbe
    v_bitop3_b32 v13, v56, v204, v13 bitop3:0xbe
    v_bitop3_b32 v13, v58, v205, v13 bitop3:0xbe
    v_bitop3_b32 v13, v60, v206, v13 bitop3:0xbe
    v_bitop3_b32 v13, v62, v207, v13 bitop3:0xbe
    v_xor_b32 v14, s91, v14
    v_lshrrev_b32 v9, 4, v14
    v_and_b32 v13, 0xff, v13
    v_or_b32 v13, v13, v9
    v_cmp_ne_u32 s[58:59], 0, v13
    s_nop 0
    s_cmp_eq_u64 s[58:59], 0
    s_cbranch_scc1 L_ok_11
    s_sub_u32 s56, s56, 1
    s_cbranch_scc0 L_poll_10
L_ok_11:
L_ok1_9:
    v_pk_fma_f32 v[252:253], v[214:215], v[62:63], v[60:61] op_sel:[1,1,0] op_sel_hi:[1,0,1] neg_lo:[1,0,0]
    v_pk_fma_f32 v[244:245], v[214:215], v[62:63], v[252:253] op_sel:[0,0,0] op_sel_hi:[0,1,1]
    v_pk_fma_f32 v[252:253], v[214:215], v[244:245], v[58:59] op_sel:[1,1,0] op_sel_hi:[1,0,1] neg_lo:[1,0,0]
    v_pk_fma_f32 v[246:247], v[214:215], v[244:245], v[252:253] op_sel:[0,0,0] op_sel_hi:[0,1,1]
    v_pk_fma_f32 v[252:253], v[214:215], v[246:247], v[56:57] op_sel:[1,1,0] op_sel_hi:[1,0,1] neg_lo:[1,0,0]
    v_pk_fma_f32 v[244:245], v[214:215], v[246:247], v[252:253] op_sel:[0,0,0] op_sel_hi:[0,1,1]
    v_pk_fma_f32 v[252:253], v[214:215], v[244:245], v[54:55] op_sel:[1,1,0] op_sel_hi:[1,0,1] neg_lo:[1,0,0]
    v_pk_fma_f32 v[246:247], v[214:215], v[244:245], v[252:253] op_sel:[0,0,0] op_sel_hi:[0,1,1]
    v_pk_fma_f32 v[252:253], v[214:215], v[246:247], v[52:53] op_sel:[1,1,0] op_sel_hi:[1,0,1] neg_lo:[1,0,0]
    v_pk_fma_f32 v[244:245], v[214:215], v[246:247], v[252:253] op_sel:[0,0,0] op_sel_hi:[0,1,1]
    v_pk_fma_f32 v[252:253], v[214:215], v[244:245], v[50:51] op_sel:[1,1,0] op_sel_hi:[1,0,1] neg_lo:[1,0,0]
    v_pk_fma_f32 v[246:247], v[214:215], v[244:245], v[252:253] op_sel:[0,0,0] op_sel_hi:[0,1,1]
    v_pk_fma_f32 v[252:253], v[214:215], v[246:247], v[48:49] op_sel:[1,1,0] op_sel_hi:[1,0,1] neg_lo:[1,0,0]
    v_pk_fma_f32 v[244:245], v[214:215], v[246:247], v[252:253] op_sel:[0,0,0] op_sel_hi:[0,1,1]
    v_pk_mul_f32 v[252:253], v[218:219], v[244:245] op_sel:[1,1] op_sel_hi:[1,0] neg_lo:[1,0]
    v_pk_fma_f32 v[48:49], v[218:219], v[244:245], v[252:253] op_sel:[0,0,0] op_sel_hi:[0,1,1]
    v_mov_b32_e64 v50, v48
    v_mov_b32 v51, v49
    s_nop 0
    v_permlane32_swap_b32 v48, v50
    v_permlane32_swap_b32 v49, v51
    v_pk_add_f32 v[48:49], v[48:49], v[50:51]
    v_fma_f32 v244, v236, v48, v238
    v_fma_f32 v245, v240, v48, v242
    v_fma_f32 v246, -v236, v49, -v239
    v_fma_f32 v247, -v240, v49, -v243
    v_fma_f32 v244, -v237, v49, v244
    v_fma_f32 v245, -v241, v49, v245
    v_fma_f32 v246, -v237, v48, v246
    v_fma_f32 v247, -v241, v48, v247
    v_pk_fma_f32 v[80:81], v[208:209], v[246:247], v[80:81] op_sel:[1,0,0] op_sel_hi:[1,1,1]
    v_pk_fma_f32 v[112:113], v[208:209], v[244:245], v[112:113] op_sel:[1,0,0] op_sel_hi:[1,1,1] neg_lo:[1,0,0] neg_hi:[1,0,0]
    v_pk_fma_f32 v[80:81], v[208:209], v[244:245], v[80:81] op_sel:[0,0,0] op_sel_hi:[0,1,1]
    v_pk_fma_f32 v[112:113], v[208:209], v[246:247], v[112:113] op_sel:[0,0,0] op_sel_hi:[0,1,1]
    v_pk_fma_f32 v[82:83], v[208:209], v[112:113], v[82:83] op_sel:[1,0,0] op_sel_hi:[1,1,1]
    v_pk_fma_f32 v[114:115], v[208:209], v[80:81], v[114:115] op_sel:[1,0,0] op_sel_hi:[1,1,1] neg_lo:[1,0,0] neg_hi:[1,0,0]
    v_pk_fma_f32 v[82:83], v[208:209], v[80:81], v[82:83] op_sel:[0,0,0] op_sel_hi:[0,1,1]
    v_pk_fma_f32 v[114:115], v[208:209], v[112:113], v[114:115] op_sel:[0,0,0] op_sel_hi:[0,1,1]
    v_pk_fma_f32 v[84:85], v[208:209], v[114:115], v[84:85] op_sel:[1,0,0] op_sel_hi:[1,1,1]
    v_pk_fma_f32 v[116:117], v[208:209], v[82:83], v[116:117] op_sel:[1,0,0] op_sel_hi:[1,1,1] neg_lo:[1,0,0] neg_hi:[1,0,0]
    v_pk_fma_f32 v[84:85], v[208:209], v[82:83], v[84:85] op_sel:[0,0,0] op_sel_hi:[0,1,1]
    v_pk_fma_f32 v[116:117], v[208:209], v[114:115], v[116:117] op_sel:[0,0,0] op_sel_hi:[0,1,1]
    v_pk_fma_f32 v[86:87], v[208:209], v[116:117], v[86:87] op_sel:[1,0,0] op_sel_hi:[1,1,1]
    v_pk_fma_f32 v[118:119], v[208:209], v[84:85], v[118:119] op_sel:[1,0,0] op_sel_hi:[1,1,1] neg_lo:[1,0,0] neg_hi:[1,0,0]
    v_pk_fma_f32 v[86:87], v[208:209], v[84:85], v[86:87] op_sel:[0,0,0] op_sel_hi:[0,1,1]
    v_pk_fma_f32 v[118:119], v[208:209], v[116:117], v[118:119] op_sel:[0,0,0] op_sel_hi:[0,1,1]
    v_pk_fma_f32 v[88:89], v[208:209], v[118:119], v[88:89] op_sel:[1,0,0] op_sel_hi:[1,1,1]
    v_pk_fma_f32 v[120:121], v[208:209], v[86:87], v[120:121] op_sel:[1,0,0] op_sel_hi:[1,1,1] neg_lo:[1,0,0] neg_hi:[1,0,0]
    v_pk_fma_f32 v[88:89], v[208:209], v[86:87], v[88:89] op_sel:[0,0,0] op_sel_hi:[0,1,1]
    v_pk_fma_f32 v[120:121], v[208:209], v[118:119], v[120:121] op_sel:[0,0,0] op_sel_hi:[0,1,1]
    v_pk_fma_f32 v[90:91], v[208:209], v[120:121], v[90:91] op_sel:[1,0,0] op_sel_hi:[1,1,1]
    v_pk_fma_f32 v[122:123], v[208:209], v[88:89], v[122:123] op_sel:[1,0,0] op_sel_hi:[1,1,1] neg_lo:[1,0,0] neg_hi:[1,0,0]
    v_pk_fma_f32 v[90:91], v[208:209], v[88:89], v[90:91] op_sel:[0,0,0] op_sel_hi:[0,1,1]
    v_pk_fma_f32 v[122:123], v[208:209], v[120:121], v[122:123] op_sel:[0,0,0] op_sel_hi:[0,1,1]
    v_pk_fma_f32 v[92:93], v[208:209], v[122:123], v[92:93] op_sel:[1,0,0] op_sel_hi:[1,1,1]
    v_pk_fma_f32 v[124:125], v[208:209], v[90:91], v[124:125] op_sel:[1,0,0] op_sel_hi:[1,1,1] neg_lo:[1,0,0] neg_hi:[1,0,0]
    v_pk_fma_f32 v[92:93], v[208:209], v[90:91], v[92:93] op_sel:[0,0,0] op_sel_hi:[0,1,1]
    v_pk_fma_f32 v[124:125], v[208:209], v[122:123], v[124:125] op_sel:[0,0,0] op_sel_hi:[0,1,1]
    v_pk_fma_f32 v[94:95], v[208:209], v[124:125], v[94:95] op_sel:[1,0,0] op_sel_hi:[1,1,1]
    v_pk_fma_f32 v[126:127], v[208:209], v[92:93], v[126:127] op_sel:[1,0,0] op_sel_hi:[1,1,1] neg_lo:[1,0,0] neg_hi:[1,0,0]
    v_pk_fma_f32 v[94:95], v[208:209], v[92:93], v[94:95] op_sel:[0,0,0] op_sel_hi:[0,1,1]
    v_pk_fma_f32 v[126:127], v[208:209], v[124:125], v[126:127] op_sel:[0,0,0] op_sel_hi:[0,1,1]
    v_cvt_pk_bf16_f32 v176, v80, v82
    v_cvt_pk_bf16_f32 v177, v84, v86
    v_cvt_pk_bf16_f32 v178, v88, v90
    v_cvt_pk_bf16_f32 v179, v92, v94
    v_cvt_pk_bf16_f32 v192, v112, v114
    v_cvt_pk_bf16_f32 v193, v116, v118
    v_cvt_pk_bf16_f32 v194, v120, v122
    v_cvt_pk_bf16_f32 v195, v124, v126
    v_permlane32_swap_b32 v176, v192
    v_permlane32_swap_b32 v177, v193
    v_permlane32_swap_b32 v178, v194
    v_permlane32_swap_b32 v179, v195
    buffer_store_dwordx4 v[176:179], v223, s[20:23], s88 offen offset:0 sc1
    v_cvt_pk_bf16_f32 v184, v81, v83
    v_cvt_pk_bf16_f32 v185, v85, v87
    v_cvt_pk_bf16_f32 v186, v89, v91
    v_cvt_pk_bf16_f32 v187, v93, v95
    v_cvt_pk_bf16_f32 v200, v113, v115
    v_cvt_pk_bf16_f32 v201, v117, v119
    v_cvt_pk_bf16_f32 v202, v121, v123
    v_cvt_pk_bf16_f32 v203, v125, v127
    v_permlane32_swap_b32 v184, v200
    v_permlane32_swap_b32 v185, v201
    v_permlane32_swap_b32 v186, v202
    v_permlane32_swap_b32 v187, v203
    buffer_store_dwordx4 v[184:187], v250, s[20:23], s88 offen offset:1024 sc1
    v_pk_fma_f32 v[96:97], v[208:209], v[126:127], v[96:97] op_sel:[1,0,0] op_sel_hi:[1,1,1]
    v_pk_fma_f32 v[128:129], v[208:209], v[94:95], v[128:129] op_sel:[1,0,0] op_sel_hi:[1,1,1] neg_lo:[1,0,0] neg_hi:[1,0,0]
    v_pk_fma_f32 v[96:97], v[208:209], v[94:95], v[96:97] op_sel:[0,0,0] op_sel_hi:[0,1,1]
    v_pk_fma_f32 v[128:129], v[208:209], v[126:127], v[128:129] op_sel:[0,0,0] op_sel_hi:[0,1,1]
    v_pk_fma_f32 v[98:99], v[208:209], v[128:129], v[98:99] op_sel:[1,0,0] op_sel_hi:[1,1,1]
    v_pk_fma_f32 v[130:131], v[208:209], v[96:97], v[130:131] op_sel:[1,0,0] op_sel_hi:[1,1,1] neg_lo:[1,0,0] neg_hi:[1,0,0]
    v_pk_fma_f32 v[98:99], v[208:209], v[96:97], v[98:99] op_sel:[0,0,0] op_sel_hi:[0,1,1]
    v_pk_fma_f32 v[130:131], v[208:209], v[128:129], v[130:131] op_sel:[0,0,0] op_sel_hi:[0,1,1]
    v_pk_fma_f32 v[100:101], v[208:209], v[130:131], v[100:101] op_sel:[1,0,0] op_sel_hi:[1,1,1]
    v_pk_fma_f32 v[132:133], v[208:209], v[98:99], v[132:133] op_sel:[1,0,0] op_sel_hi:[1,1,1] neg_lo:[1,0,0] neg_hi:[1,0,0]
    v_pk_fma_f32 v[100:101], v[208:209], v[98:99], v[100:101] op_sel:[0,0,0] op_sel_hi:[0,1,1]
    v_pk_fma_f32 v[132:133], v[208:209], v[130:131], v[132:133] op_sel:[0,0,0] op_sel_hi:[0,1,1]
    v_pk_fma_f32 v[102:103], v[208:209], v[132:133], v[102:103] op_sel:[1,0,0] op_sel_hi:[1,1,1]
    v_pk_fma_f32 v[134:135], v[208:209], v[100:101], v[134:135] op_sel:[1,0,0] op_sel_hi:[1,1,1] neg_lo:[1,0,0] neg_hi:[1,0,0]
    v_pk_fma_f32 v[102:103], v[208:209], v[100:101], v[102:103] op_sel:[0,0,0] op_sel_hi:[0,1,1]
    v_pk_fma_f32 v[134:135], v[208:209], v[132:133], v[134:135] op_sel:[0,0,0] op_sel_hi:[0,1,1]
    v_pk_fma_f32 v[104:105], v[208:209], v[134:135], v[104:105] op_sel:[1,0,0] op_sel_hi:[1,1,1]
    v_pk_fma_f32 v[136:137], v[208:209], v[102:103], v[136:137] op_sel:[1,0,0] op_sel_hi:[1,1,1] neg_lo:[1,0,0] neg_hi:[1,0,0]
    v_pk_fma_f32 v[104:105], v[208:209], v[102:103], v[104:105] op_sel:[0,0,0] op_sel_hi:[0,1,1]
    v_pk_fma_f32 v[136:137], v[208:209], v[134:135], v[136:137] op_sel:[0,0,0] op_sel_hi:[0,1,1]
    v_pk_fma_f32 v[106:107], v[208:209], v[136:137], v[106:107] op_sel:[1,0,0] op_sel_hi:[1,1,1]
    v_pk_fma_f32 v[138:139], v[208:209], v[104:105], v[138:139] op_sel:[1,0,0] op_sel_hi:[1,1,1] neg_lo:[1,0,0] neg_hi:[1,0,0]
    v_pk_fma_f32 v[106:107], v[208:209], v[104:105], v[106:107] op_sel:[0,0,0] op_sel_hi:[0,1,1]
    v_pk_fma_f32 v[138:139], v[208:209], v[136:137], v[138:139] op_sel:[0,0,0] op_sel_hi:[0,1,1]
    v_pk_fma_f32 v[108:109], v[208:209], v[138:139], v[108:109] op_sel:[1,0,0] op_sel_hi:[1,1,1]
    v_pk_fma_f32 v[140:141], v[208:209], v[106:107], v[140:141] op_sel:[1,0,0] op_sel_hi:[1,1,1] neg_lo:[1,0,0] neg_hi:[1,0,0]
    v_pk_fma_f32 v[108:109], v[208:209], v[106:107], v[108:109] op_sel:[0,0,0] op_sel_hi:[0,1,1]
    v_pk_fma_f32 v[140:141], v[208:209], v[138:139], v[140:141] op_sel:[0,0,0] op_sel_hi:[0,1,1]
    v_pk_fma_f32 v[110:111], v[208:209], v[140:141], v[110:111] op_sel:[1,0,0] op_sel_hi:[1,1,1]
    v_pk_fma_f32 v[142:143], v[208:209], v[108:109], v[142:143] op_sel:[1,0,0] op_sel_hi:[1,1,1] neg_lo:[1,0,0] neg_hi:[1,0,0]
    v_pk_fma_f32 v[110:111], v[208:209], v[108:109], v[110:111] op_sel:[0,0,0] op_sel_hi:[0,1,1]
    v_pk_fma_f32 v[142:143], v[208:209], v[140:141], v[142:143] op_sel:[0,0,0] op_sel_hi:[0,1,1]
    v_cvt_pk_bf16_f32 v180, v96, v98
    v_cvt_pk_bf16_f32 v181, v100, v102
    v_cvt_pk_bf16_f32 v182, v104, v106
    v_cvt_pk_bf16_f32 v183, v108, v110
    v_cvt_pk_bf16_f32 v196, v128, v130
    v_cvt_pk_bf16_f32 v197, v132, v134
    v_cvt_pk_bf16_f32 v198, v136, v138
    v_cvt_pk_bf16_f32 v199, v140, v142
    v_permlane32_swap_b32 v180, v196
    v_permlane32_swap_b32 v181, v197
    v_permlane32_swap_b32 v182, v198
    v_permlane32_swap_b32 v183, v199
    buffer_store_dwordx4 v[180:183], v249, s[20:23], s88 offen offset:512 sc1
    v_cvt_pk_bf16_f32 v188, v97, v99
    v_cvt_pk_bf16_f32 v189, v101, v103
    v_cvt_pk_bf16_f32 v190, v105, v107
    v_cvt_pk_bf16_f32 v191, v109, v111
    v_cvt_pk_bf16_f32 v204, v129, v131
    v_cvt_pk_bf16_f32 v205, v133, v135
    v_cvt_pk_bf16_f32 v206, v137, v139
    v_cvt_pk_bf16_f32 v207, v141, v143
    v_permlane32_swap_b32 v188, v204
    v_permlane32_swap_b32 v189, v205
    v_permlane32_swap_b32 v190, v206
    v_permlane32_swap_b32 v191, v207
    buffer_store_dwordx4 v[188:191], v251, s[20:23], s88 offen offset:1536 sc1
    buffer_store_dwordx4 v[192:195], v223, s[20:23], s89 offen offset:0 sc1
    buffer_store_dwordx4 v[196:199], v249, s[20:23], s89 offen offset:512 sc1
    buffer_store_dwordx4 v[200:203], v250, s[20:23], s89 offen offset:1024 sc1
    buffer_store_dwordx4 v[204:207], v251, s[20:23], s89 offen offset:1536 sc1
    v_cmp_ne_u32 vcc, 0, v14
    s_nop 0
    s_cmp_lg_u64 vcc, 0
    s_cselect_b32 s92, 1, 0
    s_waitcnt vmcnt(8)
    s_barrier
    s_lshl_b32 s34, s3, 12
    s_add_u32 s34, s34, 0x18000
    v_add_u32_e64 v44, s34, v223
    v_xor_b32 v45, 64, v44
    v_xor_b32 v46, 128, v44
    v_xor_b32 v47, 192, v44
    ds_write_b128 v44, v[176:179] offset:0
    ds_write_b128 v45, v[180:183] offset:512
    ds_write_b128 v46, v[184:187] offset:1024
    ds_write_b128 v47, v[188:191] offset:1536
    ds_write_b128 v44, v[192:195] offset:16384
    ds_write_b128 v45, v[196:199] offset:16896
    ds_write_b128 v46, v[200:203] offset:17408
    ds_write_b128 v47, v[204:207] offset:17920
    ds_read_b128 a[0:3], v32 offset:0
    ds_read_b128 a[4:7], v33 offset:0
    ds_read_b128 a[8:11], v32 offset:8192
    ds_read_b128 a[12:15], v33 offset:8192
    ds_read_b128 a[16:19], v34 offset:0
    ds_read_b128 a[20:23], v35 offset:0
    ds_read_b128 a[24:27], v34 offset:8192
    ds_read_b128 a[28:31], v35 offset:8192
    s_waitcnt lgkmcnt(0)
    s_barrier
    ds_read_b64_tr_b16 v[48:49], v26 offset:32768
    ds_read_b64_tr_b16 v[50:51], v27 offset:32768
    ds_read_b64_tr_b16 v[52:53], v26 offset:33024
    ds_read_b64_tr_b16 v[54:55], v27 offset:33024
    ds_read_b64_tr_b16 v[56:57], v26 offset:34816
    ds_read_b64_tr_b16 v[58:59], v27 offset:34816
    ds_read_b64_tr_b16 v[60:61], v26 offset:35072
    ds_read_b64_tr_b16 v[62:63], v27 offset:35072
    s_waitcnt lgkmcnt(0)
    s_nop 0
    v_mfma_f32_32x32x16_bf16 v[144:159], v[48:51], a[0:3], v[144:159]
    ds_read_b64_tr_b16 v[64:65], v26 offset:36864
    ds_read_b64_tr_b16 v[66:67], v27 offset:36864
    ds_read_b64_tr_b16 v[68:69], v26 offset:37120
    v_mfma_f32_32x32x16_bf16 v[144:159], v[52:55], a[4:7], v[144:159]
    ds_read_b64_tr_b16 v[70:71], v27 offset:37120
    ds_read_b64_tr_b16 v[72:73], v26 offset:38912
    ds_read_b64_tr_b16 v[74:75], v27 offset:38912
    v_mfma_f32_32x32x16_bf16 v[144:159], v[56:59], a[8:11], v[144:159]
    ds_read_b64_tr_b16 v[76:77], v26 offset:39168
    ds_read_b64_tr_b16 v[78:79], v27 offset:39168
    ds_read_b128 a[32:35], v40 offset:0
    v_mfma_f32_32x32x16_bf16 v[144:159], v[60:63], a[12:15], v[144:159]
    ds_read_b128 a[36:39], v41 offset:0
    s_waitcnt lgkmcnt(0)
    s_nop 0
    v_mfma_f32_32x32x16_bf16 v[144:159], v[64:67], a[16:19], v[144:159]
    ds_read_b64_tr_b16 v[48:49], v26 offset:49152
    ds_read_b64_tr_b16 v[50:51], v27 offset:49152
    ds_read_b64_tr_b16 v[52:53], v26 offset:49408
    v_mfma_f32_32x32x16_bf16 v[144:159], v[68:71], a[20:23], v[144:159]
    ds_read_b64_tr_b16 v[54:55], v27 offset:49408
    ds_read_b64_tr_b16 v[56:57], v26 offset:51200
    ds_read_b64_tr_b16 v[58:59], v27 offset:51200
    v_mfma_f32_32x32x16_bf16 v[144:159], v[72:75], a[24:27], v[144:159]
    ds_read_b64_tr_b16 v[60:61], v26 offset:51456
    ds_read_b64_tr_b16 v[62:63], v27 offset:51456
    ds_read_b128 a[40:43], v40 offset:8192
    v_mfma_f32_32x32x16_bf16 v[144:159], v[76:79], a[28:31], v[144:159]
    ds_read_b128 a[44:47], v41 offset:8192
    s_waitcnt lgkmcnt(0)
    s_nop 0
    v_mfma_f32_32x32x16_bf16 v[160:175], v[48:51], a[0:3], v[160:175]
    ds_read_b64_tr_b16 v[64:65], v26 offset:53248
    ds_read_b64_tr_b16 v[66:67], v27 offset:53248
    ds_read_b64_tr_b16 v[68:69], v26 offset:53504
    v_mfma_f32_32x32x16_bf16 v[160:175], v[52:55], a[4:7], v[160:175]
    ds_read_b64_tr_b16 v[70:71], v27 offset:53504
    ds_read_b64_tr_b16 v[72:73], v26 offset:55296
    ds_read_b64_tr_b16 v[74:75], v27 offset:55296
    v_mfma_f32_32x32x16_bf16 v[160:175], v[56:59], a[8:11], v[160:175]
    ds_read_b64_tr_b16 v[76:77], v26 offset:55552
    ds_read_b64_tr_b16 v[78:79], v27 offset:55552
    ds_read_b128 a[48:51], v42 offset:0
    v_mfma_f32_32x32x16_bf16 v[160:175], v[60:63], a[12:15], v[160:175]
    ds_read_b128 a[52:55], v43 offset:0
    s_waitcnt lgkmcnt(0)
    v_mfma_f32_32x32x16_bf16 v[160:175], v[64:67], a[16:19], v[160:175]
    v_mfma_f32_32x32x16_bf16 v[160:175], v[68:71], a[20:23], v[160:175]
    v_mfma_f32_32x32x16_bf16 v[160:175], v[72:75], a[24:27], v[160:175]
    ds_read_b128 a[56:59], v42 offset:8192
    v_mfma_f32_32x32x16_bf16 v[160:175], v[76:79], a[28:31], v[160:175]
    ds_read_b128 a[60:63], v43 offset:8192
    s_waitcnt vmcnt(4)
    s_cmp_lg_u32 s92, 0
    s_cbranch_scc1 L_slow_12
    buffer_store_dword v11, v10, s[20:23], s93 offen offset:0
L_join_13:
    ds_read_b128 a[64:67], v40 offset:16384
    ds_read_b128 a[68:71], v41 offset:16384
    ds_read_b128 a[72:75], v40 offset:24576
    ds_read_b128 a[76:79], v41 offset:24576
    ds_read_b128 a[80:83], v42 offset:16384
    ds_read_b128 a[84:87], v43 offset:16384
    ds_read_b128 a[88:91], v42 offset:24576
    ds_read_b128 a[92:95], v43 offset:24576
    ds_read_b128 a[96:99], v32 offset:16384
    ds_read_b128 a[100:103], v33 offset:16384
    ds_read_b128 a[104:107], v32 offset:24576
    ds_read_b128 a[108:111], v33 offset:24576
    ds_read_b128 a[112:115], v34 offset:16384
    ds_read_b128 a[116:119], v35 offset:16384
    ds_read_b128 a[120:123], v34 offset:24576
    ds_read_b128 a[124:127], v35 offset:24576
    s_waitcnt lgkmcnt(0)
    s_barrier
    s_waitcnt vmcnt(1)
    s_cmp_lg_u32 s92, 0
    s_cbranch_scc1 L_slow_14
    buffer_store_dword v11, v10, s[20:23], s93 offen offset:128
L_join_15:
    s_mov_b32 s56, 16384
L_poll_16:
    buffer_load_dword v13, v12, s[20:23], s64 offen offset:0 sc1
    s_waitcnt vmcnt(0)
    v_cmp_ne_u32 s[58:59], s7, v13
    s_nop 0
    s_cmp_eq_u64 s[58:59], 0
    s_cbranch_scc1 L_ok_17
    s_sub_u32 s56, s56, 1
    s_cbranch_scc0 L_poll_16
L_ok_17:
    s_add_u32 m0, s48, 0x20000
    s_lshl_b32 s40, s63, 15
    s_add_u32 s40, s40, s70
    buffer_load_dwordx4 v7, s[20:23], s40 offen offset:0 sc1 lds
    buffer_load_dwordx4 v7, s[20:23], s40 offen offset:1024 sc1 lds
    buffer_load_dwordx4 v7, s[20:23], s40 offen offset:2048 sc1 lds
    buffer_load_dwordx4 v7, s[20:23], s40 offen offset:3072 sc1 lds
    s_add_u32 m0, s48, 0x24000
    s_lshl_b32 s40, s44, 15
    s_add_u32 s40, s40, s70
    buffer_load_dwordx4 v7, s[20:23], s40 offen offset:0 sc1 lds
    buffer_load_dwordx4 v7, s[20:23], s40 offen offset:1024 sc1 lds
    buffer_load_dwordx4 v7, s[20:23], s40 offen offset:2048 sc1 lds
    buffer_load_dwordx4 v7, s[20:23], s40 offen offset:3072 sc1 lds
    ds_read_b128 a[128:131], v32 offset:32768
    ds_read_b128 a[132:135], v33 offset:32768
    ds_read_b128 a[136:139], v32 offset:40960
    ds_read_b128 a[140:143], v33 offset:40960
    s_add_u32 m0, s48, 0x0
    s_lshl_b32 s40, s45, 15
    s_add_u32 s40, s40, s70
    buffer_load_dwordx4 v7, s[20:23], s40 offen offset:0 sc1 lds
    ds_read_b128 a[144:147], v34 offset:32768
    ds_read_b128 a[148:151], v35 offset:32768
    ds_read_b128 a[152:155], v34 offset:40960
    ds_read_b128 a[156:159], v35 offset:40960
    buffer_load_dwordx4 v7, s[20:23], s40 offen offset:1024 sc1 lds
    ds_read_b128 a[160:163], v32 offset:49152
    ds_read_b128 a[164:167], v33 offset:49152
    ds_read_b128 a[168:171], v32 offset:57344
    ds_read_b128 a[172:175], v33 offset:57344
    buffer_load_dwordx4 v7, s[20:23], s40 offen offset:2048 sc1 lds
    ds_read_b128 a[176:179], v34 offset:49152
    ds_read_b128 a[180:183], v35 offset:49152
    ds_read_b128 a[184:187], v34 offset:57344
    ds_read_b128 a[188:191], v35 offset:57344
    buffer_load_dwordx4 v7, s[20:23], s40 offen offset:3072 sc1 lds
    ds_read_b128 a[192:195], v36 offset:0
    ds_read_b128 a[196:199], v37 offset:0
    ds_read_b128 a[200:203], v36 offset:8192
    ds_read_b128 a[204:207], v37 offset:8192
    s_add_u32 m0, s48, 0x4000
    s_lshl_b32 s40, s86, 15
    s_add_u32 s40, s40, s70
    buffer_load_dwordx4 v7, s[20:23], s40 offen offset:0 sc1 lds
    ds_read_b128 a[208:211], v38 offset:0
    ds_read_b128 a[212:215], v39 offset:0
    ds_read_b128 a[216:219], v38 offset:8192
    ds_read_b128 a[220:223], v39 offset:8192
    buffer_load_dwordx4 v7, s[20:23], s40 offen offset:1024 sc1 lds
    ds_read_b128 a[224:227], v36 offset:16384
    ds_read_b128 a[228:231], v37 offset:16384
    ds_read_b128 a[232:235], v36 offset:24576
    ds_read_b128 a[236:239], v37 offset:24576
    buffer_load_dwordx4 v7, s[20:23], s40 offen offset:2048 sc1 lds
    ds_read_b128 a[240:243], v38 offset:16384
    ds_read_b128 a[244:247], v39 offset:16384
    ds_read_b128 a[248:251], v38 offset:24576
    ds_read_b128 a[252:255], v39 offset:24576
    buffer_load_dwordx4 v7, s[20:23], s40 offen offset:3072 sc1 lds
    s_waitcnt vmcnt(12) lgkmcnt(0)
    s_barrier
    ds_read_b64_tr_b16 v[48:49], v28 offset:0
    ds_read_b64_tr_b16 v[50:51], v29 offset:0
    ds_read_b64_tr_b16 v[52:53], v28 offset:256
    ds_read_b64_tr_b16 v[54:55], v29 offset:256
    ds_read_b64_tr_b16 v[56:57], v28 offset:2048
    ds_read_b64_tr_b16 v[58:59], v29 offset:2048
    ds_read_b64_tr_b16 v[60:61], v28 offset:2304
    ds_read_b64_tr_b16 v[62:63], v29 offset:2304
    s_waitcnt lgkmcnt(0)
    s_nop 0
    v_mfma_f32_32x32x16_bf16 v[144:159], v[48:51], a[32:35], v[144:159]
    ds_read_b64_tr_b16 v[64:65], v28 offset:4096
    ds_read_b64_tr_b16 v[66:67], v29 offset:4096
    ds_read_b64_tr_b16 v[68:69], v28 offset:4352
    v_mfma_f32_32x32x16_bf16 v[144:159], v[52:55], a[36:39], v[144:159]
    ds_read_b64_tr_b16 v[70:71], v29 offset:4352
    ds_read_b64_tr_b16 v[72:73], v28 offset:6144
    ds_read_b64_tr_b16 v[74:75], v29 offset:6144
    buffer_load_dword v13, v12, s[20:23], s64 offen offset:128 sc1
    v_mfma_f32_32x32x16_bf16 v[144:159], v[56:59], a[40:43], v[144:159]
    ds_read_b64_tr_b16 v[76:77], v28 offset:6400
    ds_read_b64_tr_b16 v[78:79], v29 offset:6400
    s_add_u32 m0, s48, 0x8000
    s_lshl_b32 s40, s87, 15
    s_add_u32 s40, s40, s70
    buffer_load_dwordx4 v7, s[20:23], s40 offen offset:0 sc1 lds
    v_mfma_f32_32x32x16_bf16 v[144:159], v[60:63], a[44:47], v[144:159]
    buffer_load_dwordx4 v7, s[20:23], s40 offen offset:1024 sc1 lds
    s_waitcnt vmcnt(11) lgkmcnt(0)
    v_mfma_f32_32x32x16_bf16 v[144:159], v[64:67], a[48:51], v[144:159]
    s_barrier
    ds_read_b64_tr_b16 v[48:49], v28 offset:16384
    ds_read_b64_tr_b16 v[50:51], v29 offset:16384
    ds_read_b64_tr_b16 v[52:53], v28 offset:16640
    v_mfma_f32_32x32x16_bf16 v[144:159], v[68:71], a[52:55], v[144:159]
    ds_read_b64_tr_b16 v[54:55], v29 offset:16640
    ds_read_b64_tr_b16 v[56:57], v28 offset:18432
    ds_read_b64_tr_b16 v[58:59], v29 offset:18432
    buffer_load_dwordx4 v7, s[20:23], s40 offen offset:2048 sc1 lds
    v_mfma_f32_32x32x16_bf16 v[144:159], v[72:75], a[56:59], v[144:159]
    ds_read_b64_tr_b16 v[60:61], v28 offset:18688
    ds_read_b64_tr_b16 v[62:63], v29 offset:18688
    buffer_load_dwordx4 v7, s[20:23], s40 offen offset:3072 sc1 lds
    v_mfma_f32_32x32x16_bf16 v[144:159], v[76:79], a[60:63], v[144:159]
    s_add_u32 m0, s48, 0xc000
    s_lshl_b32 s40, s94, 15
    s_add_u32 s40, s40, s70
    buffer_load_dwordx4 v7, s[20:23], s40 offen offset:0 sc1 lds
    s_waitcnt lgkmcnt(0)
    s_nop 0
    v_mfma_f32_32x32x16_bf16 v[144:159], v[48:51], a[64:67], v[144:159]
    ds_read_b64_tr_b16 v[64:65], v28 offset:20480
    ds_read_b64_tr_b16 v[66:67], v29 offset:20480
    ds_read_b64_tr_b16 v[68:69], v28 offset:20736
    v_mfma_f32_32x32x16_bf16 v[144:159], v[52:55], a[68:71], v[144:159]
    ds_read_b64_tr_b16 v[70:71], v29 offset:20736
    ds_read_b64_tr_b16 v[72:73], v28 offset:22528
    ds_read_b64_tr_b16 v[74:75], v29 offset:22528
    buffer_load_dwordx4 v7, s[20:23], s40 offen offset:1024 sc1 lds
    v_mfma_f32_32x32x16_bf16 v[144:159], v[56:59], a[72:75], v[144:159]
    ds_read_b64_tr_b16 v[76:77], v28 offset:22784
    ds_read_b64_tr_b16 v[78:79], v29 offset:22784
    buffer_load_dwordx4 v7, s[20:23], s40 offen offset:2048 sc1 lds
    v_mfma_f32_32x32x16_bf16 v[144:159], v[60:63], a[76:79], v[144:159]
    buffer_load_dwordx4 v7, s[20:23], s40 offen offset:3072 sc1 lds
    s_waitcnt vmcnt(8)
    v_cmp_ne_u32 s[58:59], s7, v13
    s_nop 0
    s_cmp_lg_u64 s[58:59], 0
    s_cbranch_scc1 L_fslow_18
L_fback_19:
    s_waitcnt vmcnt(9) lgkmcnt(0)
    v_mfma_f32_32x32x16_bf16 v[144:159], v[64:67], a[80:83], v[144:159]
    s_barrier
    ds_read_b64_tr_b16 v[48:49], v24 offset:0
    ds_read_b64_tr_b16 v[50:51], v25 offset:0
    ds_read_b64_tr_b16 v[52:53], v24 offset:256
    v_mfma_f32_32x32x16_bf16 v[144:159], v[68:71], a[84:87], v[144:159]
    ds_read_b64_tr_b16 v[54:55], v25 offset:256
    ds_read_b64_tr_b16 v[56:57], v24 offset:2048
    ds_read_b64_tr_b16 v[58:59], v25 offset:2048
    v_mfma_f32_32x32x16_bf16 v[144:159], v[72:75], a[88:91], v[144:159]
    ds_read_b64_tr_b16 v[60:61], v24 offset:2304
    ds_read_b64_tr_b16 v[62:63], v25 offset:2304
    v_mfma_f32_32x32x16_bf16 v[144:159], v[76:79], a[92:95], v[144:159]
    s_waitcnt lgkmcnt(0)
    v_mfma_f32_32x32x16_bf16 v[144:159], v[48:51], a[96:99], v[144:159]
    ds_read_b64_tr_b16 v[64:65], v24 offset:4096
    ds_read_b64_tr_b16 v[66:67], v25 offset:4096
    ds_read_b64_tr_b16 v[68:69], v24 offset:4352
    v_mfma_f32_32x32x16_bf16 v[144:159], v[52:55], a[100:103], v[144:159]
    ds_read_b64_tr_b16 v[70:71], v25 offset:4352
    ds_read_b64_tr_b16 v[72:73], v24 offset:6144
    ds_read_b64_tr_b16 v[74:75], v25 offset:6144
    s_add_u32 m0, s48, 0x18000
    s_lshl_b32 s40, s95, 15
    s_add_u32 s40, s40, s70
    buffer_load_dwordx4 v7, s[20:23], s40 offen offset:0 sc1 lds
    v_mfma_f32_32x32x16_bf16 v[144:159], v[56:59], a[104:107], v[144:159]
    ds_read_b64_tr_b16 v[76:77], v24 offset:6400
    ds_read_b64_tr_b16 v[78:79], v25 offset:6400
    buffer_load_dwordx4 v7, s[20:23], s40 offen offset:1024 sc1 lds
    v_mfma_f32_32x32x16_bf16 v[144:159], v[60:63], a[108:111], v[144:159]
    buffer_load_dwordx4 v7, s[20:23], s40 offen offset:2048 sc1 lds
    s_waitcnt lgkmcnt(0)
    v_mfma_f32_32x32x16_bf16 v[144:159], v[64:67], a[112:115], v[144:159]
    ds_read_b64_tr_b16 v[48:49], v24 offset:16384
    ds_read_b64_tr_b16 v[50:51], v25 offset:16384
    ds_read_b64_tr_b16 v[52:53], v24 offset:16640
    v_mfma_f32_32x32x16_bf16 v[144:159], v[68:71], a[116:119], v[144:159]
    ds_read_b64_tr_b16 v[54:55], v25 offset:16640
    ds_read_b64_tr_b16 v[56:57], v24 offset:18432
    ds_read_b64_tr_b16 v[58:59], v25 offset:18432
    buffer_load_dwordx4 v7, s[20:23], s40 offen offset:3072 sc1 lds
    v_mfma_f32_32x32x16_bf16 v[144:159], v[72:75], a[120:123], v[144:159]
    ds_read_b64_tr_b16 v[60:61], v24 offset:18688
    ds_read_b64_tr_b16 v[62:63], v25 offset:18688
    s_add_u32 m0, s48, 0x1c000
    s_lshl_b32 s40, s63, 15
    s_add_u32 s40, s40, s71
    buffer_load_dwordx4 v7, s[20:23], s40 offen offset:0 sc1 lds
    v_mfma_f32_32x32x16_bf16 v[144:159], v[76:79], a[124:127], v[144:159]
    buffer_load_dwordx4 v7, s[20:23], s40 offen offset:1024 sc1 lds
    s_waitcnt lgkmcnt(0)
    s_nop 0
    v_mfma_f32_32x32x16_bf16 v[144:159], v[48:51], a[128:131], v[144:159]
    ds_read_b64_tr_b16 v[64:65], v24 offset:20480
    ds_read_b64_tr_b16 v[66:67], v25 offset:20480
    ds_read_b64_tr_b16 v[68:69], v24 offset:20736
    v_mfma_f32_32x32x16_bf16 v[144:159], v[52:55], a[132:135], v[144:159]
    ds_read_b64_tr_b16 v[70:71], v25 offset:20736
    ds_read_b64_tr_b16 v[72:73], v24 offset:22528
    ds_read_b64_tr_b16 v[74:75], v25 offset:22528
    buffer_load_dwordx4 v7, s[20:23], s40 offen offset:2048 sc1 lds
    v_mfma_f32_32x32x16_bf16 v[144:159], v[56:59], a[136:139], v[144:159]
    ds_read_b64_tr_b16 v[76:77], v24 offset:22784
    ds_read_b64_tr_b16 v[78:79], v25 offset:22784
    buffer_load_dwordx4 v7, s[20:23], s40 offen offset:3072 sc1 lds
    v_mfma_f32_32x32x16_bf16 v[144:159], v[60:63], a[140:143], v[144:159]
    s_waitcnt vmcnt(8) lgkmcnt(0)
    v_mfma_f32_32x32x16_bf16 v[144:159], v[64:67], a[144:147], v[144:159]
    s_barrier
    ds_read_b64_tr_b16 v[48:49], v24 offset:32768
    ds_read_b64_tr_b16 v[50:51], v25 offset:32768
    ds_read_b64_tr_b16 v[52:53], v24 offset:33024
    v_mfma_f32_32x32x16_bf16 v[144:159], v[68:71], a[148:151], v[144:159]
    ds_read_b64_tr_b16 v[54:55], v25 offset:33024
    ds_read_b64_tr_b16 v[56:57], v24 offset:34816
    ds_read_b64_tr_b16 v[58:59], v25 offset:34816
    v_mfma_f32_32x32x16_bf16 v[144:159], v[72:75], a[152:155], v[144:159]
    ds_read_b64_tr_b16 v[60:61], v24 offset:35072
    ds_read_b64_tr_b16 v[62:63], v25 offset:35072
    v_mfma_f32_32x32x16_bf16 v[144:159], v[76:79], a[156:159], v[144:159]
    s_waitcnt lgkmcnt(0)
    v_mfma_f32_32x32x16_bf16 v[144:159], v[48:51], a[160:163], v[144:159]
    ds_read_b64_tr_b16 v[64:65], v24 offset:36864
    ds_read_b64_tr_b16 v[66:67], v25 offset:36864
    ds_read_b64_tr_b16 v[68:69], v24 offset:37120
    v_mfma_f32_32x32x16_bf16 v[144:159], v[52:55], a[164:167], v[144:159]
    ds_read_b64_tr_b16 v[70:71], v25 offset:37120
    ds_read_b64_tr_b16 v[72:73], v24 offset:38912
    ds_read_b64_tr_b16 v[74:75], v25 offset:38912
    s_add_u32 m0, s48, 0x20000
    s_lshl_b32 s40, s44, 15
    s_add_u32 s40, s40, s71
    buffer_load_dwordx4 v7, s[20:23], s40 offen offset:0 sc1 lds
    v_mfma_f32_32x32x16_bf16 v[144:159], v[56:59], a[168:171], v[144:159]
    ds_read_b64_tr_b16 v[76:77], v24 offset:39168
    ds_read_b64_tr_b16 v[78:79], v25 offset:39168
    buffer_load_dwordx4 v7, s[20:23], s40 offen offset:1024 sc1 lds
    v_mfma_f32_32x32x16_bf16 v[144:159], v[60:63], a[172:175], v[144:159]
    buffer_load_dwordx4 v7, s[20:23], s40 offen offset:2048 sc1 lds
    s_waitcnt lgkmcnt(0)
    v_mfma_f32_32x32x16_bf16 v[144:159], v[64:67], a[176:179], v[144:159]
    ds_read_b64_tr_b16 v[48:49], v24 offset:49152
    ds_read_b64_tr_b16 v[50:51], v25 offset:49152
    ds_read_b64_tr_b16 v[52:53], v24 offset:49408
    v_mfma_f32_32x32x16_bf16 v[144:159], v[68:71], a[180:183], v[144:159]
    ds_read_b64_tr_b16 v[54:55], v25 offset:49408
    ds_read_b64_tr_b16 v[56:57], v24 offset:51200
    ds_read_b64_tr_b16 v[58:59], v25 offset:51200
    buffer_load_dwordx4 v7, s[20:23], s40 offen offset:3072 sc1 lds
    v_mfma_f32_32x32x16_bf16 v[144:159], v[72:75], a[184:187], v[144:159]
    ds_read_b64_tr_b16 v[60:61], v24 offset:51456
    ds_read_b64_tr_b16 v[62:63], v25 offset:51456
    s_add_u32 m0, s48, 0x24000
    s_lshl_b32 s40, s45, 15
    s_add_u32 s40, s40, s71
    buffer_load_dwordx4 v7, s[20:23], s40 offen offset:0 sc1 lds
    v_mfma_f32_32x32x16_bf16 v[144:159], v[76:79], a[188:191], v[144:159]
    buffer_load_dwordx4 v7, s[20:23], s40 offen offset:1024 sc1 lds
    s_waitcnt lgkmcnt(0)
    s_nop 0
    v_mfma_f32_32x32x16_bf16 v[144:159], v[48:51], a[192:195], v[144:159]
    ds_read_b64_tr_b16 v[64:65], v24 offset:53248
    ds_read_b64_tr_b16 v[66:67], v25 offset:53248
    ds_read_b64_tr_b16 v[68:69], v24 offset:53504
    v_mfma_f32_32x32x16_bf16 v[144:159], v[52:55], a[196:199], v[144:159]
    ds_read_b64_tr_b16 v[70:71], v25 offset:53504
    ds_read_b64_tr_b16 v[72:73], v24 offset:55296
    ds_read_b64_tr_b16 v[74:75], v25 offset:55296
    buffer_load_dwordx4 v7, s[20:23], s40 offen offset:2048 sc1 lds
    v_mfma_f32_32x32x16_bf16 v[144:159], v[56:59], a[200:203], v[144:159]
    ds_read_b64_tr_b16 v[76:77], v24 offset:55552
    ds_read_b64_tr_b16 v[78:79], v25 offset:55552
    buffer_load_dwordx4 v7, s[20:23], s40 offen offset:3072 sc1 lds
    v_mfma_f32_32x32x16_bf16 v[144:159], v[60:63], a[204:207], v[144:159]
    s_waitcnt vmcnt(8) lgkmcnt(0)
    v_mfma_f32_32x32x16_bf16 v[144:159], v[64:67], a[208:211], v[144:159]
    s_barrier
    ds_read_b64_tr_b16 v[48:49], v26 offset:32768
    ds_read_b64_tr_b16 v[50:51], v27 offset:32768
    ds_read_b64_tr_b16 v[52:53], v26 offset:33024
    v_mfma_f32_32x32x16_bf16 v[144:159], v[68:71], a[212:215], v[144:159]
    ds_read_b64_tr_b16 v[54:55], v27 offset:33024
    ds_read_b64_tr_b16 v[56:57], v26 offset:34816
    ds_read_b64_tr_b16 v[58:59], v27 offset:34816
    v_mfma_f32_32x32x16_bf16 v[144:159], v[72:75], a[216:219], v[144:159]
    ds_read_b64_tr_b16 v[60:61], v26 offset:35072
    ds_read_b64_tr_b16 v[62:63], v27 offset:35072
    v_mfma_f32_32x32x16_bf16 v[144:159], v[76:79], a[220:223], v[144:159]
    s_waitcnt lgkmcnt(0)
    v_mfma_f32_32x32x16_bf16 v[144:159], v[48:51], a[224:227], v[144:159]
    ds_read_b64_tr_b16 v[64:65], v26 offset:36864
    ds_read_b64_tr_b16 v[66:67], v27 offset:36864
    ds_read_b64_tr_b16 v[68:69], v26 offset:37120
    v_mfma_f32_32x32x16_bf16 v[144:159], v[52:55], a[228:231], v[144:159]
    ds_read_b64_tr_b16 v[70:71], v27 offset:37120
    ds_read_b64_tr_b16 v[72:73], v26 offset:38912
    ds_read_b64_tr_b16 v[74:75], v27 offset:38912
    s_add_u32 m0, s48, 0x0
    s_lshl_b32 s40, s86, 15
    s_add_u32 s40, s40, s71
    buffer_load_dwordx4 v7, s[20:23], s40 offen offset:0 sc1 lds
    v_mfma_f32_32x32x16_bf16 v[144:159], v[56:59], a[232:235], v[144:159]
    ds_read_b64_tr_b16 v[76:77], v26 offset:39168
    ds_read_b64_tr_b16 v[78:79], v27 offset:39168
    buffer_load_dwordx4 v7, s[20:23], s40 offen offset:1024 sc1 lds
    v_mfma_f32_32x32x16_bf16 v[144:159], v[60:63], a[236:239], v[144:159]
    buffer_load_dwordx4 v7, s[20:23], s40 offen offset:2048 sc1 lds
    s_waitcnt lgkmcnt(0)
    s_nop 0
    v_mfma_f32_32x32x16_bf16 v[144:159], v[64:67], a[240:243], v[144:159]
    ds_read_b64_tr_b16 v[48:49], v26 offset:49152
    ds_read_b64_tr_b16 v[50:51], v27 offset:49152
    ds_read_b64_tr_b16 v[52:53], v26 offset:49408
    v_mfma_f32_32x32x16_bf16 v[144:159], v[68:71], a[244:247], v[144:159]
    ds_read_b64_tr_b16 v[54:55], v27 offset:49408
    ds_read_b64_tr_b16 v[56:57], v26 offset:51200
    ds_read_b64_tr_b16 v[58:59], v27 offset:51200
    buffer_load_dwordx4 v7, s[20:23], s40 offen offset:3072 sc1 lds
    v_mfma_f32_32x32x16_bf16 v[144:159], v[72:75], a[248:251], v[144:159]
    ds_read_b64_tr_b16 v[60:61], v26 offset:51456
    ds_read_b64_tr_b16 v[62:63], v27 offset:51456
    s_add_u32 m0, s48, 0x4000
    s_lshl_b32 s40, s87, 15
    s_add_u32 s40, s40, s71
    buffer_load_dwordx4 v7, s[20:23], s40 offen offset:0 sc1 lds
    v_mfma_f32_32x32x16_bf16 v[144:159], v[76:79], a[252:255], v[144:159]
    buffer_load_dwordx4 v7, s[20:23], s40 offen offset:1024 sc1 lds
    s_waitcnt lgkmcnt(0)
    s_nop 0
    v_mfma_f32_32x32x16_bf16 v[160:175], v[48:51], a[32:35], v[160:175]
    ds_read_b64_tr_b16 v[64:65], v26 offset:53248
    ds_read_b64_tr_b16 v[66:67], v27 offset:53248
    ds_read_b64_tr_b16 v[68:69], v26 offset:53504
    v_mfma_f32_32x32x16_bf16 v[160:175], v[52:55], a[36:39], v[160:175]
    ds_read_b64_tr_b16 v[70:71], v27 offset:53504
    ds_read_b64_tr_b16 v[72:73], v26 offset:55296
    ds_read_b64_tr_b16 v[74:75], v27 offset:55296
    buffer_load_dwordx4 v7, s[20:23], s40 offen offset:2048 sc1 lds
    v_mfma_f32_32x32x16_bf16 v[160:175], v[56:59], a[40:43], v[160:175]
    ds_read_b64_tr_b16 v[76:77], v26 offset:55552
    ds_read_b64_tr_b16 v[78:79], v27 offset:55552
    buffer_load_dwordx4 v7, s[20:23], s40 offen offset:3072 sc1 lds
    v_mfma_f32_32x32x16_bf16 v[160:175], v[60:63], a[44:47], v[160:175]
    s_waitcnt vmcnt(8) lgkmcnt(0)
    v_mfma_f32_32x32x16_bf16 v[160:175], v[64:67], a[48:51], v[160:175]
    s_barrier
    ds_read_b64_tr_b16 v[48:49], v28 offset:0
    ds_read_b64_tr_b16 v[50:51], v29 offset:0
    ds_read_b64_tr_b16 v[52:53], v28 offset:256
    v_mfma_f32_32x32x16_bf16 v[160:175], v[68:71], a[52:55], v[160:175]
    ds_read_b64_tr_b16 v[54:55], v29 offset:256
    ds_read_b64_tr_b16 v[56:57], v28 offset:2048
    ds_read_b64_tr_b16 v[58:59], v29 offset:2048
    v_mfma_f32_32x32x16_bf16 v[160:175], v[72:75], a[56:59], v[160:175]
    ds_read_b64_tr_b16 v[60:61], v28 offset:2304
    ds_read_b64_tr_b16 v[62:63], v29 offset:2304
    v_mfma_f32_32x32x16_bf16 v[160:175], v[76:79], a[60:63], v[160:175]
    s_waitcnt lgkmcnt(0)
    v_mfma_f32_32x32x16_bf16 v[160:175], v[48:51], a[64:67], v[160:175]
    ds_read_b64_tr_b16 v[64:65], v28 offset:4096
    ds_read_b64_tr_b16 v[66:67], v29 offset:4096
    ds_read_b64_tr_b16 v[68:69], v28 offset:4352
    v_mfma_f32_32x32x16_bf16 v[160:175], v[52:55], a[68:71], v[160:175]
    ds_read_b64_tr_b16 v[70:71], v29 offset:4352
    ds_read_b64_tr_b16 v[72:73], v28 offset:6144
    ds_read_b64_tr_b16 v[74:75], v29 offset:6144
    s_add_u32 m0, s48, 0x8000
    s_lshl_b32 s40, s94, 15
    s_add_u32 s40, s40, s71
    buffer_load_dwordx4 v7, s[20:23], s40 offen offset:0 sc1 lds
    v_mfma_f32_32x32x16_bf16 v[160:175], v[56:59], a[72:75], v[160:175]
    ds_read_b64_tr_b16 v[76:77], v28 offset:6400
    ds_read_b64_tr_b16 v[78:79], v29 offset:6400
    buffer_load_dwordx4 v7, s[20:23], s40 offen offset:1024 sc1 lds
    v_mfma_f32_32x32x16_bf16 v[160:175], v[60:63], a[76:79], v[160:175]
    buffer_load_dwordx4 v7, s[20:23], s40 offen offset:2048 sc1 lds
    s_waitcnt lgkmcnt(0)
    v_mfma_f32_32x32x16_bf16 v[160:175], v[64:67], a[80:83], v[160:175]
    ds_read_b64_tr_b16 v[48:49], v28 offset:16384
    ds_read_b64_tr_b16 v[50:51], v29 offset:16384
    ds_read_b64_tr_b16 v[52:53], v28 offset:16640
    v_mfma_f32_32x32x16_bf16 v[160:175], v[68:71], a[84:87], v[160:175]
    ds_read_b64_tr_b16 v[54:55], v29 offset:16640
    ds_read_b64_tr_b16 v[56:57], v28 offset:18432
    ds_read_b64_tr_b16 v[58:59], v29 offset:18432
    buffer_load_dwordx4 v7, s[20:23], s40 offen offset:3072 sc1 lds
    v_mfma_f32_32x32x16_bf16 v[160:175], v[72:75], a[88:91], v[160:175]
    ds_read_b64_tr_b16 v[60:61], v28 offset:18688
    ds_read_b64_tr_b16 v[62:63], v29 offset:18688
    s_add_u32 m0, s48, 0xc000
    s_lshl_b32 s40, s95, 15
    s_add_u32 s40, s40, s71
    buffer_load_dwordx4 v7, s[20:23], s40 offen offset:0 sc1 lds
    v_mfma_f32_32x32x16_bf16 v[160:175], v[76:79], a[92:95], v[160:175]
    buffer_load_dwordx4 v7, s[20:23], s40 offen offset:1024 sc1 lds
    s_waitcnt lgkmcnt(0)
    s_nop 0
    v_mfma_f32_32x32x16_bf16 v[160:175], v[48:51], a[96:99], v[160:175]
    ds_read_b64_tr_b16 v[64:65], v28 offset:20480
    ds_read_b64_tr_b16 v[66:67], v29 offset:20480
    ds_read_b64_tr_b16 v[68:69], v28 offset:20736
    v_mfma_f32_32x32x16_bf16 v[160:175], v[52:55], a[100:103], v[160:175]
    ds_read_b64_tr_b16 v[70:71], v29 offset:20736
    ds_read_b64_tr_b16 v[72:73], v28 offset:22528
    ds_read_b64_tr_b16 v[74:75], v29 offset:22528
    buffer_load_dwordx4 v7, s[20:23], s40 offen offset:2048 sc1 lds
    v_mfma_f32_32x32x16_bf16 v[160:175], v[56:59], a[104:107], v[160:175]
    ds_read_b64_tr_b16 v[76:77], v28 offset:22784
    ds_read_b64_tr_b16 v[78:79], v29 offset:22784
    buffer_load_dwordx4 v7, s[20:23], s40 offen offset:3072 sc1 lds
    v_mfma_f32_32x32x16_bf16 v[160:175], v[60:63], a[108:111], v[160:175]
    s_waitcnt vmcnt(8) lgkmcnt(0)
    v_mfma_f32_32x32x16_bf16 v[160:175], v[64:67], a[112:115], v[160:175]
    s_barrier
    ds_read_b64_tr_b16 v[48:49], v24 offset:0
    ds_read_b64_tr_b16 v[50:51], v25 offset:0
    ds_read_b64_tr_b16 v[52:53], v24 offset:256
    v_mfma_f32_32x32x16_bf16 v[160:175], v[68:71], a[116:119], v[160:175]
    ds_read_b64_tr_b16 v[54:55], v25 offset:256
    ds_read_b64_tr_b16 v[56:57], v24 offset:2048
    ds_read_b64_tr_b16 v[58:59], v25 offset:2048
    v_mfma_f32_32x32x16_bf16 v[160:175], v[72:75], a[120:123], v[160:175]
    ds_read_b64_tr_b16 v[60:61], v24 offset:2304
    ds_read_b64_tr_b16 v[62:63], v25 offset:2304
    v_mfma_f32_32x32x16_bf16 v[160:175], v[76:79], a[124:127], v[160:175]
    s_waitcnt lgkmcnt(0)
    v_mfma_f32_32x32x16_bf16 v[160:175], v[48:51], a[128:131], v[160:175]
    ds_read_b64_tr_b16 v[64:65], v24 offset:4096
    ds_read_b64_tr_b16 v[66:67], v25 offset:4096
    ds_read_b64_tr_b16 v[68:69], v24 offset:4352
    v_mfma_f32_32x32x16_bf16 v[160:175], v[52:55], a[132:135], v[160:175]
    ds_read_b64_tr_b16 v[70:71], v25 offset:4352
    ds_read_b64_tr_b16 v[72:73], v24 offset:6144
    ds_read_b64_tr_b16 v[74:75], v25 offset:6144
    v_mfma_f32_32x32x16_bf16 v[160:175], v[56:59], a[136:139], v[160:175]
    ds_read_b64_tr_b16 v[76:77], v24 offset:6400
    ds_read_b64_tr_b16 v[78:79], v25 offset:6400
    s_add_u32 s33, s68, 0
    buffer_store_dword v144, v2, s[24:27], s33 offen sc1
    v_mfma_f32_32x32x16_bf16 v[160:175], v[60:63], a[140:143], v[160:175]
    s_add_u32 s33, s68, 4096
    buffer_store_dword v145, v2, s[24:27], s33 offen sc1
    s_waitcnt lgkmcnt(0)
    s_nop 0
    v_mfma_f32_32x32x16_bf16 v[160:175], v[64:67], a[144:147], v[160:175]
    ds_read_b64_tr_b16 v[48:49], v24 offset:16384
    ds_read_b64_tr_b16 v[50:51], v25 offset:16384
    ds_read_b64_tr_b16 v[52:53], v24 offset:16640
    v_mfma_f32_32x32x16_bf16 v[160:175], v[68:71], a[148:151], v[160:175]
    ds_read_b64_tr_b16 v[54:55], v25 offset:16640
    ds_read_b64_tr_b16 v[56:57], v24 offset:18432
    ds_read_b64_tr_b16 v[58:59], v25 offset:18432
    v_mfma_f32_32x32x16_bf16 v[160:175], v[72:75], a[152:155], v[160:175]
    ds_read_b64_tr_b16 v[60:61], v24 offset:18688
    ds_read_b64_tr_b16 v[62:63], v25 offset:18688
    s_add_u32 s33, s68, 8192
    buffer_store_dword v146, v2, s[24:27], s33 offen sc1
    v_mfma_f32_32x32x16_bf16 v[160:175], v[76:79], a[156:159], v[160:175]
    s_add_u32 s33, s68, 12288
    buffer_store_dword v147, v2, s[24:27], s33 offen sc1
    s_waitcnt lgkmcnt(0)
    s_nop 0
    v_mfma_f32_32x32x16_bf16 v[160:175], v[48:51], a[160:163], v[160:175]
    ds_read_b64_tr_b16 v[64:65], v24 offset:20480
    ds_read_b64_tr_b16 v[66:67], v25 offset:20480
    ds_read_b64_tr_b16 v[68:69], v24 offset:20736
    v_mfma_f32_32x32x16_bf16 v[160:175], v[52:55], a[164:167], v[160:175]
    ds_read_b64_tr_b16 v[70:71], v25 offset:20736
    ds_read_b64_tr_b16 v[72:73], v24 offset:22528
    ds_read_b64_tr_b16 v[74:75], v25 offset:22528
    v_mfma_f32_32x32x16_bf16 v[160:175], v[56:59], a[168:171], v[160:175]
    ds_read_b64_tr_b16 v[76:77], v24 offset:22784
    ds_read_b64_tr_b16 v[78:79], v25 offset:22784
    s_add_u32 s33, s68, 32768
    buffer_store_dword v148, v2, s[24:27], s33 offen sc1
    v_mfma_f32_32x32x16_bf16 v[160:175], v[60:63], a[172:175], v[160:175]
    s_add_u32 s33, s68, 36864
    buffer_store_dword v149, v2, s[24:27], s33 offen sc1
    s_waitcnt vmcnt(6) lgkmcnt(0)
    v_mfma_f32_32x32x16_bf16 v[160:175], v[64:67], a[176:179], v[160:175]
    s_barrier
    ds_read_b64_tr_b16 v[48:49], v24 offset:32768
    ds_read_b64_tr_b16 v[50:51], v25 offset:32768
    ds_read_b64_tr_b16 v[52:53], v24 offset:33024
    v_mfma_f32_32x32x16_bf16 v[160:175], v[68:71], a[180:183], v[160:175]
    ds_read_b64_tr_b16 v[54:55], v25 offset:33024
    ds_read_b64_tr_b16 v[56:57], v24 offset:34816
    ds_read_b64_tr_b16 v[58:59], v25 offset:34816
    v_mfma_f32_32x32x16_bf16 v[160:175], v[72:75], a[184:187], v[160:175]
    ds_read_b64_tr_b16 v[60:61], v24 offset:35072
    ds_read_b64_tr_b16 v[62:63], v25 offset:35072
    s_add_u32 s33, s68, 40960
    buffer_store_dword v150, v2, s[24:27], s33 offen sc1
    v_mfma_f32_32x32x16_bf16 v[160:175], v[76:79], a[188:191], v[160:175]
    s_add_u32 s33, s68, 45056
    buffer_store_dword v151, v2, s[24:27], s33 offen sc1
    s_waitcnt lgkmcnt(0)
    s_nop 0
    v_mfma_f32_32x32x16_bf16 v[160:175], v[48:51], a[192:195], v[160:175]
    ds_read_b64_tr_b16 v[64:65], v24 offset:36864
    ds_read_b64_tr_b16 v[66:67], v25 offset:36864
    ds_read_b64_tr_b16 v[68:69], v24 offset:37120
    v_mfma_f32_32x32x16_bf16 v[160:175], v[52:55], a[196:199], v[160:175]
    ds_read_b64_tr_b16 v[70:71], v25 offset:37120
    ds_read_b64_tr_b16 v[72:73], v24 offset:38912
    ds_read_b64_tr_b16 v[74:75], v25 offset:38912
    v_mfma_f32_32x32x16_bf16 v[160:175], v[56:59], a[200:203], v[160:175]
    ds_read_b64_tr_b16 v[76:77], v24 offset:39168
    ds_read_b64_tr_b16 v[78:79], v25 offset:39168
    s_add_u32 s33, s68, 65536
    buffer_store_dword v152, v2, s[24:27], s33 offen sc1
    v_mfma_f32_32x32x16_bf16 v[160:175], v[60:63], a[204:207], v[160:175]
    s_add_u32 s33, s68, 69632
    buffer_store_dword v153, v2, s[24:27], s33 offen sc1
    s_waitcnt lgkmcnt(0)
    s_nop 0
    v_mfma_f32_32x32x16_bf16 v[160:175], v[64:67], a[208:211], v[160:175]
    ds_read_b64_tr_b16 v[48:49], v24 offset:49152
    ds_read_b64_tr_b16 v[50:51], v25 offset:49152
    ds_read_b64_tr_b16 v[52:53], v24 offset:49408
    v_mfma_f32_32x32x16_bf16 v[160:175], v[68:71], a[212:215], v[160:175]
    ds_read_b64_tr_b16 v[54:55], v25 offset:49408
    ds_read_b64_tr_b16 v[56:57], v24 offset:51200
    ds_read_b64_tr_b16 v[58:59], v25 offset:51200
    v_mfma_f32_32x32x16_bf16 v[160:175], v[72:75], a[216:219], v[160:175]
    ds_read_b64_tr_b16 v[60:61], v24 offset:51456
    ds_read_b64_tr_b16 v[62:63], v25 offset:51456
    s_add_u32 s33, s68, 73728
    buffer_store_dword v154, v2, s[24:27], s33 offen sc1
    v_mfma_f32_32x32x16_bf16 v[160:175], v[76:79], a[220:223], v[160:175]
    s_add_u32 s33, s68, 77824
    buffer_store_dword v155, v2, s[24:27], s33 offen sc1
    s_waitcnt lgkmcnt(0)
    s_nop 0
    v_mfma_f32_32x32x16_bf16 v[160:175], v[48:51], a[224:227], v[160:175]
    ds_read_b64_tr_b16 v[64:65], v24 offset:53248
    ds_read_b64_tr_b16 v[66:67], v25 offset:53248
    ds_read_b64_tr_b16 v[68:69], v24 offset:53504
    v_mfma_f32_32x32x16_bf16 v[160:175], v[52:55], a[228:231], v[160:175]
    ds_read_b64_tr_b16 v[70:71], v25 offset:53504
    ds_read_b64_tr_b16 v[72:73], v24 offset:55296
    ds_read_b64_tr_b16 v[74:75], v25 offset:55296
    v_mfma_f32_32x32x16_bf16 v[160:175], v[56:59], a[232:235], v[160:175]
    ds_read_b64_tr_b16 v[76:77], v24 offset:55552
    ds_read_b64_tr_b16 v[78:79], v25 offset:55552
    s_add_u32 s33, s68, 98304
    buffer_store_dword v156, v2, s[24:27], s33 offen sc1
    v_mfma_f32_32x32x16_bf16 v[160:175], v[60:63], a[236:239], v[160:175]
    s_add_u32 s33, s68, 102400
    buffer_store_dword v157, v2, s[24:27], s33 offen sc1
    s_waitcnt lgkmcnt(0)
    v_mfma_f32_32x32x16_bf16 v[160:175], v[64:67], a[240:243], v[160:175]
    v_mfma_f32_32x32x16_bf16 v[160:175], v[68:71], a[244:247], v[160:175]
    v_mfma_f32_32x32x16_bf16 v[160:175], v[72:75], a[248:251], v[160:175]
    s_add_u32 s33, s68, 106496
    buffer_store_dword v158, v2, s[24:27], s33 offen sc1
    v_mfma_f32_32x32x16_bf16 v[160:175], v[76:79], a[252:255], v[160:175]
    s_add_u32 s33, s68, 110592
    buffer_store_dword v159, v2, s[24:27], s33 offen sc1
    s_add_u32 s33, s69, 0
    s_nop 8
    s_nop 0
    buffer_store_dword v160, v2, s[24:27], s33 offen sc1
    s_add_u32 s33, s69, 4096
    buffer_store_dword v161, v2, s[24:27], s33 offen sc1
    s_add_u32 s33, s69, 8192
    buffer_store_dword v162, v2, s[24:27], s33 offen sc1
    s_add_u32 s33, s69, 12288
    buffer_store_dword v163, v2, s[24:27], s33 offen sc1
    s_add_u32 s33, s69, 32768
    buffer_store_dword v164, v2, s[24:27], s33 offen sc1
    s_add_u32 s33, s69, 36864
    buffer_store_dword v165, v2, s[24:27], s33 offen sc1
    s_add_u32 s33, s69, 40960
    buffer_store_dword v166, v2, s[24:27], s33 offen sc1
    s_add_u32 s33, s69, 45056
    buffer_store_dword v167, v2, s[24:27], s33 offen sc1
    s_add_u32 s33, s69, 65536
    buffer_store_dword v168, v2, s[24:27], s33 offen sc1
    s_add_u32 s33, s69, 69632
    buffer_store_dword v169, v2, s[24:27], s33 offen sc1
    s_add_u32 s33, s69, 73728
    buffer_store_dword v170, v2, s[24:27], s33 offen sc1
    s_add_u32 s33, s69, 77824
    buffer_store_dword v171, v2, s[24:27], s33 offen sc1
    s_add_u32 s33, s69, 98304
    buffer_store_dword v172, v2, s[24:27], s33 offen sc1
    s_add_u32 s33, s69, 102400
    buffer_store_dword v173, v2, s[24:27], s33 offen sc1
    s_add_u32 s33, s69, 106496
    buffer_store_dword v174, v2, s[24:27], s33 offen sc1
    s_add_u32 s33, s69, 110592
    buffer_store_dword v175, v2, s[24:27], s33 offen sc1
    s_cmp_eq_u32 s67, 3840
    s_cbranch_scc0 L_notag_20
    buffer_store_dword v11, v10, s[20:23], 0 offen offset:0 sc1
L_notag_20:
    s_endpgm
L_slow_12:
    buffer_store_dword v11, v10, s[20:23], s93 offen offset:0 sc1
    s_branch L_join_13
L_slow_14:
    buffer_store_dword v11, v10, s[20:23], s93 offen offset:128 sc1
    s_branch L_join_15
L_fslow_18:
    s_mov_b32 s56, 16384
L_poll_21:
    buffer_load_dword v13, v12, s[20:23], s64 offen offset:128 sc1
    s_waitcnt vmcnt(0)
    v_cmp_ne_u32 s[58:59], s7, v13
    s_nop 0
    s_cmp_eq_u64 s[58:59], 0
    s_cbranch_scc1 L_ok_22
    s_sub_u32 s56, s56, 1
    s_cbranch_scc0 L_poll_21
L_ok_22:
    s_branch L_fback_19
L_end:
    s_endpgm
.fill 8192, 4, 0xBF810000
.section .rodata,"a"
.p2align 6
.amdhsa_kernel concat_heads__ssm_conv_s5__linear_kernel_hedgehog__prompt_kernel
  .amdhsa_next_free_vgpr 512
  .amdhsa_next_free_sgpr 102
  .amdhsa_accum_offset 256
  .amdhsa_group_segment_fixed_size 0
  .amdhsa_kernarg_size 128
  .amdhsa_user_sgpr_count 2
  .amdhsa_user_sgpr_kernarg_segment_ptr 1
  .amdhsa_system_sgpr_workgroup_id_x 1
.end_amdhsa_kernel
```
